```python
import torch

def _softmax(x, axis=-1):
    return torch.softmax(x, dim=axis)
def _gelu(x):
    return torch.nn.functional.gelu(x, approximate="tanh")
def _silu(x):
    return torch.nn.functional.silu(x)
def _sigmoid(x):
    return torch.sigmoid(x)
def _layernorm(x, axis=-1, eps=1e-5):
    m = x.mean(dim=axis, keepdim=True)
    v = x.var(dim=axis, keepdim=True, unbiased=False)
    return (x - m) / torch.sqrt(v + eps)
def _scatter_add(tgt, idx, src, axis=0):
    return tgt.clone().index_add_(axis, idx, src)
def _segment_sum(src, seg, n):
    out = torch.zeros((n,) + src.shape[1:], dtype=src.dtype)
    return out.index_add_(0, seg, src)
def _pad(x, pw):
    flat = tuple(v for pair in reversed(pw) for v in pair)
    return torch.nn.functional.pad(x, flat)

kernel_name = 'interleave_layers__linear_attn_block__mha_block__prompt'

def setup_inputs():

    _w = (lambda a: (lambda t: t.to(torch.bfloat16) if t.is_floating_point() else t)(torch.as_tensor(a)))
    def _A_setup():
        B, S, D = 1, 2048, 576
        return {
            "x": _w((lambda *s: torch.randn(*s, dtype=torch.bfloat16) * 0.05)(B, S, D)),
            "wqkv": _w((lambda *s: torch.randn(*s, dtype=torch.bfloat16) * 0.05)(D, 3 * D)),
            "wo": _w((lambda *s: torch.randn(*s, dtype=torch.bfloat16) * 0.05)(D, D)),
        }
    _A_in = _A_setup()

    def _B_setup():
        B, S, D, H = 1, 2048, 576, 32
        return {
            "x": _w((lambda *s: torch.randn(*s, dtype=torch.bfloat16) * 0.05)(B, S, D)),
            "wqkv": _w((lambda *s: torch.randn(*s, dtype=torch.bfloat16) * 0.1)(D, 3 * D)),
            "wo": _w((lambda *s: torch.randn(*s, dtype=torch.bfloat16) * 0.05)(D, D)),
        }
    _B_in = _B_setup()

    return {
        "A_x": _A_in["x"],
        "A_wqkv": _A_in["wqkv"],
        "A_wo": _A_in["wo"],
        "B_x": _B_in["x"],
        "B_wqkv": _B_in["wqkv"],
        "B_wo": _B_in["wo"],
    }

def reference(A_x, A_wqkv, A_wo, B_x, B_wqkv, B_wo):
    def _A_ref(x, wqkv, wo):
        B, S, D = x.shape
        H = 32; Dh = D // H
        qkv = (lambda x, *d: x.permute(*d))((x @ wqkv).reshape(B, S, 3, H, Dh), 2, 0, 3, 1, 4)
        q, k, v = qkv[0], qkv[1], qkv[2]
        phi = lambda t: torch.where(t > 0, t + 1, torch.exp(t)) + 1e-6
        pq, pk = phi(q), phi(k)
        kv = torch.einsum("bhsd,bhse->bhde", pk, v)
        z = torch.einsum("bhsd->bhd", pk)
        num = torch.einsum("bhqd,bhde->bhqe", pq, kv)
        den = torch.einsum("bhqd,bhd->bhq", pq, z)[..., None] + 1e-6
        o = num / den
        return (lambda x, *d: x.permute(*d))(o, 0, 2, 1, 3).reshape(B, S, D) @ wo

    def _B_ref(x, wqkv, wo):
        B, S, D = x.shape
        H = 32
        Dh = D // H
        qkv = (lambda x, *d: x.permute(*d))((x @ wqkv).reshape(B, S, 3, H, Dh), 2, 0, 3, 1, 4)
        q, k, v = qkv[0], qkv[1], qkv[2]
        scores = torch.einsum("bhqd,bhkd->bhqk", q, k) * (Dh ** -0.5)
        p = _softmax(scores, axis=-1)
        o = torch.einsum("bhqk,bhkd->bhqd", p, v)
        return (lambda x, *d: x.permute(*d))(o, 0, 2, 1, 3).reshape(B, S, D) @ wo

    x = A_x
    x = x + _A_ref(_layernorm(x, axis=-1), A_wqkv, A_wo)
    x = x + _B_ref(_layernorm(x, axis=-1), B_wqkv, B_wo)
    x = x + _A_ref(_layernorm(x, axis=-1), A_wqkv, A_wo)
    x = x + _B_ref(_layernorm(x, axis=-1), B_wqkv, B_wo)
    return x
```

```asm
; @launch kernel=prep_kernel grid=(432,1,1) block=(768,1,1) lds=29696
; @launch kernel=qkv_a1_kernel grid=(256,1,1) block=(512,1,1) lds=138752
; @launch kernel=out_a1_kernel grid=(256,1,1) block=(1024,1,1) lds=157696
; @launch kernel=qkv_b1_kernel grid=(256,1,1) block=(512,1,1) lds=138752
; @launch kernel=attn_kernel grid=(256,1,1) block=(1024,1,1) lds=155648
; @launch kernel=out_b1_kernel grid=(256,1,1) block=(512,1,1) lds=157696
; @launch kernel=qkv_a2_kernel grid=(256,1,1) block=(512,1,1) lds=138752
; @launch kernel=out_a2_kernel grid=(256,1,1) block=(1024,1,1) lds=157696
; @launch kernel=qkv_b2_kernel grid=(256,1,1) block=(512,1,1) lds=138752
; @launch kernel=attn_kernel grid=(256,1,1) block=(1024,1,1) lds=155648
; @launch kernel=out_b2_kernel grid=(256,1,1) block=(512,1,1) lds=157696
.amdgcn_target "amdgcn-amd-amdhsa--gfx950"
.text
.p2align 8
L_text_start:
.globl prep_kernel
.p2align 8
.type prep_kernel,@function
prep_kernel:
    s_cmp_ge_u32 s2, 432
    s_cbranch_scc1 L_prep_end
    s_load_dwordx2 s[4:5], s[0:1], 64
    s_load_dwordx4 s[20:23], s[0:1], 0
    s_load_dwordx2 s[24:25], s[0:1], 16
    s_load_dwordx4 s[56:59], s[0:1], 32
    v_and_b32 v3, 63, v0
    v_lshrrev_b32 v4, 6, v0
    v_lshlrev_b32 v1, 7, v0
    v_readfirstlane_b32 s35, v4
    v_and_b32 v0, 255, v0
    v_lshlrev_b32 v5, 4, v3
    s_lshr_b32 s46, s35, 2
    s_and_b32 s35, s35, 3
    s_cmp_ge_u32 s2, 192
    s_cbranch_scc1 L_prep_x0
    s_mul_i32 s47, s46, 9216
    s_cmp_ge_u32 s2, 16
    s_cbranch_scc1 L_prep_kernel_npc1
    s_getpc_b64 s[52:53]
L_prep_kernel_pc2:
    s_sub_u32 s52, s52, L_prep_kernel_pc2-L_text_start
    s_subb_u32 s53, s53, 0
    s_mov_b32 s54, L_text_end-L_text_start
    s_mov_b32 s55, 0x00020000
    buffer_load_dword v60, v1, s[52:55], 0 offen
L_prep_kernel_npc1:
    s_cmp_ge_u32 s2, 96
    s_cselect_b32 s30, 1, 0
    s_cselect_b32 s31, 96, 0
    s_sub_u32 s31, s2, s31
    s_add_u32 s36, s30, 1
    s_mul_i32 s32, s31, 10923
    s_lshr_b32 s32, s32, 16
    s_mul_i32 s33, s32, 6
    s_sub_u32 s33, s31, s33
    s_mul_i32 s48, s33, 3
    s_add_u32 s48, s48, s46
    s_mul_i32 s37, s32, 72
    s_mul_i32 s38, s48, 110592
    s_add_u32 s37, s37, s38
    v_min_u32 v10, 239, v0
    v_mul_u32_u24 v11, 2185, v10
    v_lshrrev_b32 v11, 16, v11
    v_mul_u32_u24 v12, 30, v11
    v_sub_u32 v12, v10, v12
    v_mul_u32_u24 v13, 52, v12
    v_lshrrev_b32 v13, 8, v13
    v_mul_u32_u24 v14, 5, v13
    v_sub_u32 v14, v12, v14
    v_and_b32 v16, 1, v13
    v_lshrrev_b32 v13, 1, v13
    v_mul_u32_u24 v15, 1152, v13
    v_mul_u32_u24 v17, 36, v16
    v_lshl_add_u32 v17, v14, 3, v17
    v_add_u32 v15, v15, v17
    v_lshl_add_u32 v17, v14, 1, v16
    v_lshl_add_u32 v18, v16, 2, v14
    v_cmp_le_u32 vcc, s36, v13
    v_cmp_eq_u32 s[50:51], 4, v14
    s_nop 0
    v_cndmask_b32 v17, v17, v18, vcc
    v_lshlrev_b32 v17, 3, v17
    v_lshl_add_u32 v17, v13, 6, v17
    v_cmp_eq_u32 vcc, 2, v13
    v_lshlrev_b32 v18, 2, v13
    s_nop 0
    v_cndmask_b32_e64 v18, v18, 16, vcc
    v_lshl_add_u32 v18, v16, 3, v18
    v_mul_u32_u24 v19, 3456, v11
    v_add3_u32 v15, v15, v19, s37
    s_waitcnt lgkmcnt(0)
    s_cmp_eq_u32 s30, 0
    s_cselect_b32 s8, s22, s56
    s_cselect_b32 s9, s23, s57
    s_mov_b32 s10, 1990656
    s_mov_b32 s11, 0x00020000
    s_mov_b32 s34, 0
    buffer_load_dwordx2 v[32:33], v15, s[8:11], s34 offen
    s_mov_b32 s34, 27648
    buffer_load_dwordx2 v[34:35], v15, s[8:11], s34 offen
    s_mov_b32 s34, 55296
    buffer_load_dwordx2 v[36:37], v15, s[8:11], s34 offen
    s_mov_b32 s34, 82944
    buffer_load_dwordx2 v[38:39], v15, s[8:11], s34 offen
    s_mov_b32 s16, s4
    s_mov_b32 s17, s5
    s_mov_b32 s18, 0x8000000
    s_mov_b32 s19, 0x00020000
    v_mul_u32_u24 v19, 288, v11
    v_add_u32 v19, s47, v19
    v_add_u32 v20, v19, v17
    v_add_u32 v21, v19, v18
    v_lshrrev_b32 v6, 4, v3
    v_bfe_u32 v8, v3, 2, 2
    v_and_b32 v9, 3, v3
    v_lshrrev_b32 v7, 1, v6
    v_lshl_add_u32 v7, v7, 3, v8
    v_mul_u32_u24 v7, 288, v7
    v_and_b32 v10, 1, v6
    v_lshl_add_u32 v7, v10, 5, v7
    v_lshl_add_u32 v7, v9, 3, v7
    s_lshl_b32 s38, s35, 6
    s_add_u32 s38, s38, s47
    v_add_u32 v7, s38, v7
    s_mul_i32 s38, s32, 36
    s_lshl_b32 s39, s48, 1
    s_add_u32 s38, s38, s39
    s_lshl_b32 s38, s38, 2
    s_add_u32 s38, s38, s35
    s_lshl_b32 s38, s38, 10
    s_add_u32 s38, s38, 0x2000000
    s_mul_i32 s39, s30, 0x240000
    s_add_u32 s38, s38, s39
    s_add_u32 s40, s38, 4096
    s_lshl_b32 s39, s33, 4
    s_add_u32 s39, s39, s32
    s_lshl_b32 s39, s39, 9
    s_add_u32 s39, s39, 0x1480000
    s_mul_i32 s41, s30, 49152
    s_add_u32 s39, s39, s41
    s_lshl_b32 s41, s46, 9
    s_lshl_b32 s42, s35, 7
    s_add_u32 s41, s41, s42
    s_add_u32 s41, s41, 27648
    v_and_b32 v11, 31, v3
    v_lshl_add_u32 v10, v11, 2, s41
    s_cmp_eq_u32 s35, 3
    s_cselect_b32 s34, 16, 32
    v_cmp_gt_u32 vcc, s34, v11
    v_mov_b32 v12, 0x40000000
    s_mov_b32 s42, 0x3f803f80
    v_cndmask_b32 v5, v12, v5, vcc
    v_mov_b32 v48, 0
    s_waitcnt vmcnt(0)
    s_mov_b64 exec, s[50:51]
    ds_write_b32 v21, v32 offset:192
    ds_write_b32 v21, v34 offset:2496
    ds_write_b32 v21, v36 offset:4800
    ds_write_b32 v21, v38 offset:7104
    s_not_b64 exec, exec
    ds_write_b64 v20, v[32:33] offset:0
    ds_write_b64 v20, v[34:35] offset:2304
    ds_write_b64 v20, v[36:37] offset:4608
    ds_write_b64 v20, v[38:39] offset:6912
    s_mov_b64 exec, -1
    s_waitcnt lgkmcnt(0)
    s_barrier
    ds_read_b64_tr_b16 v[32:33], v7 offset:0
    ds_read_b64_tr_b16 v[34:35], v7 offset:1152
    ds_read_b64_tr_b16 v[36:37], v7 offset:4608
    ds_read_b64_tr_b16 v[38:39], v7 offset:5760
    s_waitcnt lgkmcnt(0)
    buffer_store_dwordx4 v[32:35], v5, s[16:19], s38 offen
    buffer_store_dwordx4 v[36:39], v5, s[16:19], s40 offen
    v_dot2_f32_bf16 v48, v32, s42, v48
    v_dot2_f32_bf16 v48, v33, s42, v48
    v_dot2_f32_bf16 v48, v34, s42, v48
    v_dot2_f32_bf16 v48, v35, s42, v48
    v_dot2_f32_bf16 v48, v36, s42, v48
    v_dot2_f32_bf16 v48, v37, s42, v48
    v_dot2_f32_bf16 v48, v38, s42, v48
    v_dot2_f32_bf16 v48, v39, s42, v48
    s_nop 2
    v_mov_b32 v49, v48
    s_nop 1
    v_permlane32_swap_b32 v49, v48
    s_nop 1
    v_add_f32 v48, v48, v49
    ds_write_b32 v10, v48
    s_waitcnt lgkmcnt(0)
    s_barrier
    s_cmp_lg_u32 s46, 0
    s_cbranch_scc1 L_prep_end
    s_cmp_ge_u32 s35, 2
    s_cbranch_scc1 L_prep_end
    v_lshlrev_b32 v10, 2, v0
    ds_read_b32 v12, v10 offset:27648
    ds_read_b32 v13, v10 offset:28160
    ds_read_b32 v14, v10 offset:28672
    s_waitcnt lgkmcnt(0)
    v_add_f32 v12, v12, v13
    v_add_f32 v12, v12, v14
    buffer_store_dword v12, v10, s[16:19], s39 offen
    s_endpgm
L_prep_x0:
    s_cmp_ge_u32 s2, 320
    s_cbranch_scc1 L_prep_zero
    s_sub_u32 s3, s2, 192
    s_cmp_lg_u32 s46, 0
    s_cbranch_scc1 L_prep_end
    s_and_b32 s28, s3, 1
    s_lshl_b32 s28, s28, 2
    s_add_u32 s28, s28, s35
    s_lshr_b32 s3, s3, 1
    s_mul_i32 s7, s3, 36864
    s_mul_i32 s29, s28, 144
    s_add_u32 s30, s7, s29
    s_mul_i32 s29, s28, 4608
    s_add_u32 s6, s7, s29
    s_add_u32 s6, s6, 0x1d00000
    v_and_b32 v1, 31, v3
    v_lshrrev_b32 v2, 5, v3
    v_mul_u32_u24 v4, 1152, v1
    v_mul_u32_u24 v7, 80, v2
    v_add_u32 v4, v4, v7
    v_lshl_add_u32 v6, v2, 30, v4
    s_waitcnt lgkmcnt(0)
    s_mov_b32 s8, s20
    s_mov_b32 s9, s21
    s_mov_b32 s10, 2359296
    s_mov_b32 s11, 0x00020000
    buffer_load_dwordx4 v[32:35], v4, s[8:11], s30 offen offset:0
    buffer_load_dwordx4 v[36:39], v4, s[8:11], s30 offen offset:16
    buffer_load_dwordx4 v[40:43], v4, s[8:11], s30 offen offset:32
    buffer_load_dwordx4 v[44:47], v4, s[8:11], s30 offen offset:48
    buffer_load_dwordx4 v[48:51], v6, s[8:11], s30 offen offset:64
    s_mov_b32 s16, s4
    s_mov_b32 s17, s5
    s_mov_b32 s18, 0x8000000
    s_mov_b32 s19, 0x00020000
    s_mov_b32 s42, 0x3f803f80
    v_mul_u32_u24 v7, 2560, v2
    v_lshl_add_u32 v7, v1, 4, v7
    v_lshl_add_u32 v11, v2, 30, v7
    v_lshlrev_b32 v12, 7, v1
    v_lshl_add_u32 v12, v2, 3, v12
    s_lshl_b32 s29, s3, 12
    s_lshl_b32 s28, s28, 4
    s_add_u32 s28, s28, s29
    s_add_u32 s28, s28, 0x1500000
    v_mov_b32 v8, 0
    v_mov_b32 v9, 0
    s_waitcnt vmcnt(0)
    buffer_store_dwordx4 v[32:35], v7, s[16:19], s6 offen offset:0
    v_dot2_f32_bf16 v8, v32, s42, v8
    v_dot2_f32_bf16 v9, v32, v32, v9
    v_dot2_f32_bf16 v8, v33, s42, v8
    v_dot2_f32_bf16 v9, v33, v33, v9
    v_dot2_f32_bf16 v8, v34, s42, v8
    v_dot2_f32_bf16 v9, v34, v34, v9
    v_dot2_f32_bf16 v8, v35, s42, v8
    v_dot2_f32_bf16 v9, v35, v35, v9
    buffer_store_dwordx4 v[36:39], v7, s[16:19], s6 offen offset:512
    v_dot2_f32_bf16 v8, v36, s42, v8
    v_dot2_f32_bf16 v9, v36, v36, v9
    v_dot2_f32_bf16 v8, v37, s42, v8
    v_dot2_f32_bf16 v9, v37, v37, v9
    v_dot2_f32_bf16 v8, v38, s42, v8
    v_dot2_f32_bf16 v9, v38, v38, v9
    v_dot2_f32_bf16 v8, v39, s42, v8
    v_dot2_f32_bf16 v9, v39, v39, v9
    buffer_store_dwordx4 v[40:43], v7, s[16:19], s6 offen offset:1024
    v_dot2_f32_bf16 v8, v40, s42, v8
    v_dot2_f32_bf16 v9, v40, v40, v9
    v_dot2_f32_bf16 v8, v41, s42, v8
    v_dot2_f32_bf16 v9, v41, v41, v9
    v_dot2_f32_bf16 v8, v42, s42, v8
    v_dot2_f32_bf16 v9, v42, v42, v9
    v_dot2_f32_bf16 v8, v43, s42, v8
    v_dot2_f32_bf16 v9, v43, v43, v9
    buffer_store_dwordx4 v[44:47], v7, s[16:19], s6 offen offset:1536
    v_dot2_f32_bf16 v8, v44, s42, v8
    v_dot2_f32_bf16 v9, v44, v44, v9
    v_dot2_f32_bf16 v8, v45, s42, v8
    v_dot2_f32_bf16 v9, v45, v45, v9
    v_dot2_f32_bf16 v8, v46, s42, v8
    v_dot2_f32_bf16 v9, v46, v46, v9
    v_dot2_f32_bf16 v8, v47, s42, v8
    v_dot2_f32_bf16 v9, v47, v47, v9
    buffer_store_dwordx4 v[48:51], v11, s[16:19], s6 offen offset:2048
    v_dot2_f32_bf16 v8, v48, s42, v8
    v_dot2_f32_bf16 v9, v48, v48, v9
    v_dot2_f32_bf16 v8, v49, s42, v8
    v_dot2_f32_bf16 v9, v49, v49, v9
    v_dot2_f32_bf16 v8, v50, s42, v8
    v_dot2_f32_bf16 v9, v50, v50, v9
    v_dot2_f32_bf16 v8, v51, s42, v8
    v_dot2_f32_bf16 v9, v51, v51, v9
    s_nop 2
    buffer_store_dwordx2 v[8:9], v12, s[16:19], s28 offen
    s_endpgm
L_prep_zero:
    s_cmp_lt_u32 s2, 336
    s_cbranch_scc1 L_prep_kernel_z3
    s_mul_i32 s47, s46, 9216
    v_lshrrev_b32 v6, 4, v3
    v_bfe_u32 v8, v3, 2, 2
    v_and_b32 v9, 3, v3
    s_waitcnt lgkmcnt(0)
    s_mov_b32 s26, s58
    s_mov_b32 s27, s59
    s_mov_b32 s16, s4
    s_mov_b32 s17, s5
    s_mov_b32 s18, 0x8000000
    s_mov_b32 s19, 0x00020000
    s_sub_u32 s29, s2, 336
    s_mul_i32 s29, s29, 3
    s_add_u32 s29, s29, s46
    s_cmp_ge_u32 s29, 144
    s_cselect_b32 s30, 1, 0
    s_mul_i32 s31, s30, 144
    s_sub_u32 s31, s29, s31
    s_mul_i32 s32, s31, 3641
    s_lshr_b32 s32, s32, 16
    s_mul_i32 s33, s32, 18
    s_sub_u32 s33, s31, s33
    s_cmp_eq_u32 s30, 0
    s_cselect_b32 s8, s24, s26
    s_cselect_b32 s9, s25, s27
    s_mov_b32 s10, 663552
    s_mov_b32 s11, 0x00020000
    s_mul_i32 s37, s32, 144
    s_mul_i32 s38, s33, 41472
    s_sub_u32 s39, s33, 16
    s_cmp_eq_u32 s30, 0
    s_cselect_b64 s[52:53], -1, 0
    s_cselect_b32 s40, 1, 4
    s_mul_i32 s39, s39, s40
    s_mul_i32 s39, s39, 82944
    s_cmp_ge_u32 s33, 16
    s_cselect_b32 s38, s39, s38
    s_cselect_b64 s[50:51], -1, 0
    s_add_u32 s37, s37, s38
    v_add_u32 v10, 0, v0
    v_mul_u32_u24 v11, 7282, v10
    v_lshrrev_b32 v11, 16, v11
    v_mul_u32_u24 v12, 9, v11
    v_sub_u32 v12, v10, v12
    v_lshrrev_b32 v13, 4, v11
    v_mul_u32_u24 v13, 18, v13
    v_bfe_u32 v14, v11, 3, 1
    v_lshl_add_u32 v13, v14, 2, v13
    v_and_b32 v14, 3, v11
    v_add_u32 v13, v13, v14
    v_bfe_u32 v14, v11, 2, 1
    v_lshl_add_u32 v13, v14, 3, v13
    v_lshrrev_b32 v14, 1, v11
    v_and_b32 v16, 3, v14
    v_lshrrev_b32 v17, 3, v11
    v_lshl_add_u32 v16, v16, 3, v17
    v_cndmask_b32 v14, v14, v16, s[52:53]
    v_mul_u32_u24 v14, 18, v14
    v_and_b32 v16, 1, v11
    v_add3_u32 v14, v14, v16, 16
    v_cndmask_b32 v13, v13, v14, s[50:51]
    v_mul_u32_u24 v15, 1152, v13
    v_lshl_add_u32 v15, v12, 4, v15
    v_add_u32 v15, s37, v15
    buffer_load_dwordx4 v[32:35], v15, s[8:11], 0 offen
    v_mul_u32_u24 v15, 160, v11
    v_lshrrev_b32 v13, 3, v11
    v_lshl_add_u32 v15, v13, 7, v15
    v_lshl_add_u32 v15, v12, 4, v15
    v_add_u32 v20, s47, v15
    v_add_u32 v10, 256, v0
    v_min_u32 v10, 287, v10
    v_mul_u32_u24 v11, 7282, v10
    v_lshrrev_b32 v11, 16, v11
    v_mul_u32_u24 v12, 9, v11
    v_sub_u32 v12, v10, v12
    v_lshrrev_b32 v13, 4, v11
    v_mul_u32_u24 v13, 18, v13
    v_bfe_u32 v14, v11, 3, 1
    v_lshl_add_u32 v13, v14, 2, v13
    v_and_b32 v14, 3, v11
    v_add_u32 v13, v13, v14
    v_bfe_u32 v14, v11, 2, 1
    v_lshl_add_u32 v13, v14, 3, v13
    v_lshrrev_b32 v14, 1, v11
    v_and_b32 v16, 3, v14
    v_lshrrev_b32 v17, 3, v11
    v_lshl_add_u32 v16, v16, 3, v17
    v_cndmask_b32 v14, v14, v16, s[52:53]
    v_mul_u32_u24 v14, 18, v14
    v_and_b32 v16, 1, v11
    v_add3_u32 v14, v14, v16, 16
    v_cndmask_b32 v13, v13, v14, s[50:51]
    v_mul_u32_u24 v15, 1152, v13
    v_lshl_add_u32 v15, v12, 4, v15
    v_add_u32 v15, s37, v15
    buffer_load_dwordx4 v[36:39], v15, s[8:11], 0 offen
    v_mul_u32_u24 v15, 160, v11
    v_lshrrev_b32 v13, 3, v11
    v_lshl_add_u32 v15, v13, 7, v15
    v_lshl_add_u32 v15, v12, 4, v15
    v_add_u32 v21, s47, v15
    s_waitcnt vmcnt(0)
    ds_write_b128 v20, v[32:35]
    ds_write_b128 v21, v[36:39]
    v_mul_u32_u24 v7, 1408, v6
    v_mul_u32_u24 v10, 160, v8
    v_lshl_add_u32 v10, v9, 3, v10
    s_lshl_b32 s38, s35, 5
    s_add_u32 s38, s38, s47
    v_add3_u32 v7, v7, v10, s38
    s_mul_i32 s38, s32, 82944
    s_lshr_b32 s39, s33, 1
    s_mul_i32 s39, s39, 9216
    s_add_u32 s38, s38, s39
    s_mul_i32 s39, s30, 0xc0000
    s_add_u32 s38, s38, s39
    s_add_u32 s38, s38, 0x1840000
    s_and_b32 s39, s33, 1
    s_lshl_b32 s40, s39, 9
    s_add_u32 s40, s40, s38
    s_add_u32 s40, s40, 8192
    s_lshl_b32 s39, s39, 12
    s_add_u32 s38, s38, s39
    s_lshl_b32 s39, s35, 10
    s_add_u32 s38, s38, s39
    v_and_b32 v10, 15, v3
    v_lshlrev_b32 v11, 4, v10
    v_lshl_add_u32 v11, v6, 7, v11
    v_cmp_gt_u32 vcc, 8, v10
    v_mov_b32 v12, 0x40000000
    s_nop 0
    v_cndmask_b32 v11, v12, v11, vcc
    s_waitcnt lgkmcnt(0)
    s_barrier
    ds_read_b64_tr_b16 v[32:33], v7 offset:0
    ds_read_b64_tr_b16 v[34:35], v7 offset:640
    ds_read_b64_tr_b16 v[36:37], v7 offset:128
    ds_read_b64_tr_b16 v[38:39], v7 offset:768
    s_waitcnt lgkmcnt(0)
    buffer_store_dwordx4 v[32:35], v5, s[16:19], s38 offen
    s_cmp_lg_u32 s35, 0
    s_cbranch_scc1 L_prep_end
    buffer_store_dwordx4 v[36:39], v11, s[16:19], s40 offen
    s_endpgm
L_prep_kernel_z3:
    s_sub_u32 s3, s2, 320
    s_mul_i32 s3, s3, 3
    s_add_u32 s3, s3, s46
    s_lshl_b32 s6, s3, 12
    s_add_u32 s7, s6, 0x1400000
    s_add_u32 s6, s6, 0x1466000
    s_cmp_lt_u32 s3, 38
    s_cselect_b32 s6, s7, s6
    s_cmp_lt_u32 s3, 38
    s_cselect_b32 s6, s6, 0x40000000
    v_lshlrev_b32 v1, 4, v0
    v_mov_b32 v4, 0
    v_mov_b32 v5, 0
    v_mov_b32 v6, 0
    v_mov_b32 v7, 0
    s_waitcnt lgkmcnt(0)
    s_mov_b32 s16, s4
    s_mov_b32 s17, s5
    s_mov_b32 s18, 0x8000000
    s_mov_b32 s19, 0x00020000
    buffer_store_dwordx4 v[4:7], v1, s[16:19], s6 offen
    s_waitcnt vmcnt(0)
L_prep_end:
    s_endpgm
.globl qkv_a1_kernel
.p2align 8
.type qkv_a1_kernel,@function
qkv_a1_kernel:
    s_mov_b32 s58, 0x1d00000
    s_mov_b32 s59, 0x1400000
    s_mov_b32 s57, 0x1500000
    s_mov_b32 s60, 0x1
    s_mov_b32 s61, 0x0
    s_branch L_qkvA
.globl qkv_a2_kernel
.p2align 8
.type qkv_a2_kernel,@function
qkv_a2_kernel:
    s_mov_b32 s58, 0x240000
    s_mov_b32 s59, 0x1413000
    s_mov_b32 s57, 0x1580000
    s_mov_b32 s60, 0x0
    s_mov_b32 s61, 0x0
    s_branch L_qkvA
.p2align 8
L_qkvA:
    s_cmp_ge_u32 s2, 256
    s_cbranch_scc1 L_L_qkvA_end
    s_load_dwordx2 s[4:5], s[0:1], 64
L_L_qkvA_fused:
    v_lshrrev_b32 v4, 6, v0
    s_and_b32 s28, s2, 7
    s_lshr_b32 s29, s2, 3
    v_readfirstlane_b32 s35, v4
    s_lshr_b32 s31, s28, 1
    s_lshl_b32 s31, s31, 2
    s_lshr_b32 s32, s29, 3
    s_add_u32 s31, s31, s32
    s_and_b32 s30, s28, 1
    s_lshl_b32 s30, s30, 3
    s_and_b32 s32, s29, 7
    s_add_u32 s30, s30, s32
    v_and_b32 v3, 63, v0
    v_and_b32 v5, 31, v3
    v_lshrrev_b32 v6, 5, v3
    v_lshlrev_b32 v176, 4, v3
    s_lshl_b32 s43, s30, 1
    s_cmp_lt_u32 s35, 4
    s_cbranch_scc1 L_L_qkvA_loader
    s_sub_u32 s40, s35, 4
    s_lshl_b32 s34, s40, 11
    v_add_u32 v177, s34, v176
    v_add_u32 v178, 0x10000, v177
    v_add_u32 v179, 8192, v176
    v_add_u32 v180, 0x10000, v179
    s_lshl_b32 s38, s31, 2
    s_add_u32 s38, s38, s40
    s_lshl_b32 s44, s38, 5
    s_add_u32 s44, s44, s43
    s_mul_i32 s44, s44, 1152
    s_add_u32 s44, s44, 0x1a00000
    s_mul_i32 s46, s40, 5120
    s_add_u32 s46, s46, 32768
    v_mov_b32 v198, 0x358637bd
    v_mov_b32 v199, 0x358637bd
    v_mov_b32 v200, 0x3fb8aa3b
    v_mov_b32 v201, 0x3fb8aa3b
    v_mov_b32 v202, 0xb5c1a2a0
    v_mov_b32 v203, 0xb5c1a2a0
    v_mul_u32_u24 v7, 1152, v6
    v_lshl_add_u32 v204, v5, 4, v7
    v_lshl_add_u32 v205, v5, 2, v7
    v_and_b32 v9, 3, v5
    v_bfe_u32 v10, v5, 3, 1
    v_lshl_add_u32 v9, v10, 2, v9
    v_lshlrev_b32 v9, 1, v9
    v_bfe_u32 v10, v5, 2, 1
    v_lshrrev_b32 v11, 4, v5
    v_lshl_add_u32 v9, v10, 8, v9
    v_mul_u32_u24 v12, 2560, v11
    v_add_u32 v9, v9, v12
    v_lshl_add_u32 v9, v6, 6, v9
    v_add_u32 v209, s46, v9
    v_add_u32 v206, s46, v176
    v_lshlrev_b32 v14, 3, v3
    v_add_u32 v14, 136704, v14
    s_lshl_b32 s34, s40, 8
    s_add_u32 s34, s34, 134144
    v_lshl_add_u32 v7, v5, 3, s34
    s_lshl_b32 s34, s40, 7
    s_add_u32 s34, s34, 136192
    v_lshl_add_u32 v8, v6, 4, s34
    s_waitcnt lgkmcnt(0)
    s_mov_b32 s16, s4
    s_mov_b32 s17, s5
    s_mov_b32 s18, 0x8000000
    s_mov_b32 s19, 0x00020000
    s_barrier
    ds_read_b128 v[80:83], v177 offset:0
    ds_read_b128 v[88:91], v179 offset:0
    ds_read_b128 v[96:99], v179 offset:1024
    ds_read_b128 v[104:107], v179 offset:2048
    ds_read_b128 v[112:115], v179 offset:3072
    ds_read_b128 v[84:87], v177 offset:1024
    ds_read_b128 v[92:95], v179 offset:4096
    ds_read_b128 v[100:103], v179 offset:5120
    ds_read_b128 v[108:111], v179 offset:6144
    ds_read_b128 v[116:119], v179 offset:7168
    s_waitcnt lgkmcnt(0)
    v_mfma_f32_32x32x16_bf16 v[32:47], v[80:83], v[96:99], 0
    ds_read_b128 v[120:123], v177 offset:16384
    ds_read_b128 v[128:131], v179 offset:16384
    v_mfma_f32_32x32x16_bf16 v[48:63], v[80:83], v[104:107], 0
    ds_read_b128 v[136:139], v179 offset:17408
    ds_read_b128 v[144:147], v179 offset:18432
    v_mfma_f32_32x32x16_bf16 v[64:79], v[112:115], v[80:83], 0
    ds_read_b128 v[152:155], v179 offset:19456
    ds_read_b128 v[124:127], v177 offset:17408
    v_mfma_f32_32x32x16_bf16 v[16:31], v[88:91], v[80:83], 0
    ds_read_b128 v[132:135], v179 offset:20480
    ds_read_b128 v[140:143], v179 offset:21504
    v_mfma_f32_32x32x16_bf16 v[32:47], v[84:87], v[100:103], v[32:47]
    ds_read_b128 v[148:151], v179 offset:22528
    ds_read_b128 v[156:159], v179 offset:23552
    v_mfma_f32_32x32x16_bf16 v[48:63], v[84:87], v[108:111], v[48:63]
    v_mfma_f32_32x32x16_bf16 v[64:79], v[116:119], v[84:87], v[64:79]
    v_mfma_f32_32x32x16_bf16 v[16:31], v[92:95], v[84:87], v[16:31]
    s_waitcnt lgkmcnt(0)
    s_barrier
    v_mfma_f32_32x32x16_bf16 v[32:47], v[120:123], v[136:139], v[32:47]
    ds_read_b128 v[80:83], v177 offset:32768
    ds_read_b128 v[88:91], v179 offset:32768
    v_mfma_f32_32x32x16_bf16 v[48:63], v[120:123], v[144:147], v[48:63]
    ds_read_b128 v[96:99], v179 offset:33792
    ds_read_b128 v[104:107], v179 offset:34816
    v_mfma_f32_32x32x16_bf16 v[64:79], v[152:155], v[120:123], v[64:79]
    ds_read_b128 v[112:115], v179 offset:35840
    ds_read_b128 v[84:87], v177 offset:33792
    v_mfma_f32_32x32x16_bf16 v[16:31], v[128:131], v[120:123], v[16:31]
    ds_read_b128 v[92:95], v179 offset:36864
    ds_read_b128 v[100:103], v179 offset:37888
    v_mfma_f32_32x32x16_bf16 v[32:47], v[124:127], v[140:143], v[32:47]
    ds_read_b128 v[108:111], v179 offset:38912
    ds_read_b128 v[116:119], v179 offset:39936
    v_mfma_f32_32x32x16_bf16 v[48:63], v[124:127], v[148:151], v[48:63]
    v_mfma_f32_32x32x16_bf16 v[64:79], v[156:159], v[124:127], v[64:79]
    v_mfma_f32_32x32x16_bf16 v[16:31], v[132:135], v[124:127], v[16:31]
    s_waitcnt lgkmcnt(0)
    s_barrier
    v_mfma_f32_32x32x16_bf16 v[32:47], v[80:83], v[96:99], v[32:47]
    ds_read_b128 v[120:123], v177 offset:49152
    ds_read_b128 v[128:131], v179 offset:49152
    v_mfma_f32_32x32x16_bf16 v[48:63], v[80:83], v[104:107], v[48:63]
    ds_read_b128 v[136:139], v179 offset:50176
    ds_read_b128 v[144:147], v179 offset:51200
    v_mfma_f32_32x32x16_bf16 v[64:79], v[112:115], v[80:83], v[64:79]
    ds_read_b128 v[152:155], v179 offset:52224
    ds_read_b128 v[124:127], v177 offset:50176
    v_mfma_f32_32x32x16_bf16 v[16:31], v[88:91], v[80:83], v[16:31]
    ds_read_b128 v[132:135], v179 offset:53248
    ds_read_b128 v[140:143], v179 offset:54272
    v_mfma_f32_32x32x16_bf16 v[32:47], v[84:87], v[100:103], v[32:47]
    ds_read_b128 v[148:151], v179 offset:55296
    ds_read_b128 v[156:159], v179 offset:56320
    v_mfma_f32_32x32x16_bf16 v[48:63], v[84:87], v[108:111], v[48:63]
    v_mfma_f32_32x32x16_bf16 v[64:79], v[116:119], v[84:87], v[64:79]
    v_mfma_f32_32x32x16_bf16 v[16:31], v[92:95], v[84:87], v[16:31]
    s_waitcnt lgkmcnt(0)
    s_barrier
    v_mfma_f32_32x32x16_bf16 v[32:47], v[120:123], v[136:139], v[32:47]
    ds_read_b128 v[80:83], v178 offset:0
    ds_read_b128 v[88:91], v180 offset:0
    v_mfma_f32_32x32x16_bf16 v[48:63], v[120:123], v[144:147], v[48:63]
    ds_read_b128 v[96:99], v180 offset:1024
    ds_read_b128 v[104:107], v180 offset:2048
    v_mfma_f32_32x32x16_bf16 v[64:79], v[152:155], v[120:123], v[64:79]
    ds_read_b128 v[112:115], v180 offset:3072
    ds_read_b128 v[84:87], v178 offset:1024
    v_mfma_f32_32x32x16_bf16 v[16:31], v[128:131], v[120:123], v[16:31]
    ds_read_b128 v[92:95], v180 offset:4096
    ds_read_b128 v[100:103], v180 offset:5120
    v_mfma_f32_32x32x16_bf16 v[32:47], v[124:127], v[140:143], v[32:47]
    ds_read_b128 v[108:111], v180 offset:6144
    ds_read_b128 v[116:119], v180 offset:7168
    v_mfma_f32_32x32x16_bf16 v[48:63], v[124:127], v[148:151], v[48:63]
    v_mfma_f32_32x32x16_bf16 v[64:79], v[156:159], v[124:127], v[64:79]
    v_mfma_f32_32x32x16_bf16 v[16:31], v[132:135], v[124:127], v[16:31]
    s_waitcnt lgkmcnt(0)
    s_barrier
    v_mfma_f32_32x32x16_bf16 v[32:47], v[80:83], v[96:99], v[32:47]
    ds_read_b128 v[120:123], v178 offset:16384
    ds_read_b128 v[128:131], v180 offset:16384
    v_mfma_f32_32x32x16_bf16 v[48:63], v[80:83], v[104:107], v[48:63]
    ds_read_b128 v[136:139], v180 offset:17408
    ds_read_b128 v[144:147], v180 offset:18432
    v_mfma_f32_32x32x16_bf16 v[64:79], v[112:115], v[80:83], v[64:79]
    ds_read_b128 v[152:155], v180 offset:19456
    ds_read_b128 v[124:127], v178 offset:17408
    v_mfma_f32_32x32x16_bf16 v[16:31], v[88:91], v[80:83], v[16:31]
    ds_read_b128 v[132:135], v180 offset:20480
    ds_read_b128 v[140:143], v180 offset:21504
    v_mfma_f32_32x32x16_bf16 v[32:47], v[84:87], v[100:103], v[32:47]
    ds_read_b128 v[148:151], v180 offset:22528
    ds_read_b128 v[156:159], v180 offset:23552
    v_mfma_f32_32x32x16_bf16 v[48:63], v[84:87], v[108:111], v[48:63]
    v_mfma_f32_32x32x16_bf16 v[64:79], v[116:119], v[84:87], v[64:79]
    v_mfma_f32_32x32x16_bf16 v[16:31], v[92:95], v[84:87], v[16:31]
    s_waitcnt lgkmcnt(0)
    s_barrier
    v_mfma_f32_32x32x16_bf16 v[32:47], v[120:123], v[136:139], v[32:47]
    ds_read_b128 v[80:83], v178 offset:32768
    ds_read_b128 v[88:91], v180 offset:32768
    v_mfma_f32_32x32x16_bf16 v[48:63], v[120:123], v[144:147], v[48:63]
    ds_read_b128 v[96:99], v180 offset:33792
    ds_read_b128 v[104:107], v180 offset:34816
    v_mfma_f32_32x32x16_bf16 v[64:79], v[152:155], v[120:123], v[64:79]
    ds_read_b128 v[112:115], v180 offset:35840
    ds_read_b128 v[84:87], v178 offset:33792
    v_mfma_f32_32x32x16_bf16 v[16:31], v[128:131], v[120:123], v[16:31]
    ds_read_b128 v[92:95], v180 offset:36864
    ds_read_b128 v[100:103], v180 offset:37888
    v_mfma_f32_32x32x16_bf16 v[32:47], v[124:127], v[140:143], v[32:47]
    ds_read_b128 v[108:111], v180 offset:38912
    ds_read_b128 v[116:119], v180 offset:39936
    v_mfma_f32_32x32x16_bf16 v[48:63], v[124:127], v[148:151], v[48:63]
    v_mfma_f32_32x32x16_bf16 v[64:79], v[156:159], v[124:127], v[64:79]
    v_mfma_f32_32x32x16_bf16 v[16:31], v[132:135], v[124:127], v[16:31]
    s_waitcnt lgkmcnt(0)
    s_barrier
    v_mfma_f32_32x32x16_bf16 v[32:47], v[80:83], v[96:99], v[32:47]
    ds_read_b128 v[120:123], v178 offset:49152
    ds_read_b128 v[128:131], v180 offset:49152
    v_mfma_f32_32x32x16_bf16 v[48:63], v[80:83], v[104:107], v[48:63]
    ds_read_b128 v[136:139], v180 offset:50176
    ds_read_b128 v[144:147], v180 offset:51200
    v_mfma_f32_32x32x16_bf16 v[64:79], v[112:115], v[80:83], v[64:79]
    ds_read_b128 v[152:155], v180 offset:52224
    ds_read_b128 v[124:127], v178 offset:50176
    v_mfma_f32_32x32x16_bf16 v[16:31], v[88:91], v[80:83], v[16:31]
    ds_read_b128 v[132:135], v180 offset:53248
    ds_read_b128 v[140:143], v180 offset:54272
    v_mfma_f32_32x32x16_bf16 v[32:47], v[84:87], v[100:103], v[32:47]
    ds_read_b128 v[148:151], v180 offset:55296
    ds_read_b128 v[156:159], v180 offset:56320
    v_mfma_f32_32x32x16_bf16 v[48:63], v[84:87], v[108:111], v[48:63]
    v_mfma_f32_32x32x16_bf16 v[64:79], v[116:119], v[84:87], v[64:79]
    v_mfma_f32_32x32x16_bf16 v[16:31], v[92:95], v[84:87], v[16:31]
    s_waitcnt lgkmcnt(0)
    s_barrier
    v_mfma_f32_32x32x16_bf16 v[32:47], v[120:123], v[136:139], v[32:47]
    ds_read_b128 v[80:83], v177 offset:0
    ds_read_b128 v[88:91], v179 offset:0
    v_mfma_f32_32x32x16_bf16 v[48:63], v[120:123], v[144:147], v[48:63]
    ds_read_b128 v[96:99], v179 offset:1024
    ds_read_b128 v[104:107], v179 offset:2048
    v_mfma_f32_32x32x16_bf16 v[64:79], v[152:155], v[120:123], v[64:79]
    ds_read_b128 v[112:115], v179 offset:3072
    ds_read_b128 v[84:87], v177 offset:1024
    v_mfma_f32_32x32x16_bf16 v[16:31], v[128:131], v[120:123], v[16:31]
    ds_read_b128 v[92:95], v179 offset:4096
    ds_read_b128 v[100:103], v179 offset:5120
    v_mfma_f32_32x32x16_bf16 v[32:47], v[124:127], v[140:143], v[32:47]
    ds_read_b128 v[108:111], v179 offset:6144
    ds_read_b128 v[116:119], v179 offset:7168
    v_mfma_f32_32x32x16_bf16 v[48:63], v[124:127], v[148:151], v[48:63]
    v_mfma_f32_32x32x16_bf16 v[64:79], v[156:159], v[124:127], v[64:79]
    v_mfma_f32_32x32x16_bf16 v[16:31], v[132:135], v[124:127], v[16:31]
    s_waitcnt lgkmcnt(0)
    s_barrier
    v_mfma_f32_32x32x16_bf16 v[32:47], v[80:83], v[96:99], v[32:47]
    ds_read_b128 v[120:123], v177 offset:16384
    ds_read_b128 v[128:131], v179 offset:16384
    v_mfma_f32_32x32x16_bf16 v[48:63], v[80:83], v[104:107], v[48:63]
    ds_read_b128 v[136:139], v179 offset:17408
    ds_read_b128 v[144:147], v179 offset:18432
    v_mfma_f32_32x32x16_bf16 v[64:79], v[112:115], v[80:83], v[64:79]
    ds_read_b128 v[152:155], v179 offset:19456
    ds_read_b128 v[124:127], v177 offset:17408
    v_mfma_f32_32x32x16_bf16 v[16:31], v[88:91], v[80:83], v[16:31]
    ds_read_b128 v[132:135], v179 offset:20480
    ds_read_b128 v[140:143], v179 offset:21504
    v_mfma_f32_32x32x16_bf16 v[32:47], v[84:87], v[100:103], v[32:47]
    ds_read_b128 v[148:151], v179 offset:22528
    ds_read_b128 v[156:159], v179 offset:23552
    v_mfma_f32_32x32x16_bf16 v[48:63], v[84:87], v[108:111], v[48:63]
    v_mfma_f32_32x32x16_bf16 v[64:79], v[116:119], v[84:87], v[64:79]
    v_mfma_f32_32x32x16_bf16 v[16:31], v[92:95], v[84:87], v[16:31]
    s_waitcnt lgkmcnt(0)
    s_barrier
    v_mfma_f32_32x32x16_bf16 v[32:47], v[120:123], v[136:139], v[32:47]
    ds_read_b128 v[80:83], v177 offset:32768
    ds_read_b128 v[88:91], v179 offset:32768
    v_mfma_f32_32x32x16_bf16 v[48:63], v[120:123], v[144:147], v[48:63]
    ds_read_b128 v[96:99], v179 offset:33792
    ds_read_b128 v[104:107], v179 offset:34816
    v_mfma_f32_32x32x16_bf16 v[64:79], v[152:155], v[120:123], v[64:79]
    ds_read_b128 v[112:115], v179 offset:35840
    ds_read_b128 v[84:87], v177 offset:33792
    v_mfma_f32_32x32x16_bf16 v[16:31], v[128:131], v[120:123], v[16:31]
    ds_read_b128 v[92:95], v179 offset:36864
    ds_read_b128 v[100:103], v179 offset:37888
    v_mfma_f32_32x32x16_bf16 v[32:47], v[124:127], v[140:143], v[32:47]
    ds_read_b128 v[108:111], v179 offset:38912
    ds_read_b128 v[116:119], v179 offset:39936
    v_mfma_f32_32x32x16_bf16 v[48:63], v[124:127], v[148:151], v[48:63]
    v_mfma_f32_32x32x16_bf16 v[64:79], v[156:159], v[124:127], v[64:79]
    v_mfma_f32_32x32x16_bf16 v[16:31], v[132:135], v[124:127], v[16:31]
    s_waitcnt lgkmcnt(0)
    s_barrier
    v_mfma_f32_32x32x16_bf16 v[32:47], v[80:83], v[96:99], v[32:47]
    ds_read_b128 v[120:123], v177 offset:49152
    ds_read_b128 v[128:131], v179 offset:49152
    v_mfma_f32_32x32x16_bf16 v[48:63], v[80:83], v[104:107], v[48:63]
    ds_read_b128 v[136:139], v179 offset:50176
    ds_read_b128 v[144:147], v179 offset:51200
    v_mfma_f32_32x32x16_bf16 v[64:79], v[112:115], v[80:83], v[64:79]
    ds_read_b128 v[152:155], v179 offset:52224
    ds_read_b128 v[124:127], v177 offset:50176
    v_mfma_f32_32x32x16_bf16 v[16:31], v[88:91], v[80:83], v[16:31]
    ds_read_b128 v[132:135], v179 offset:53248
    ds_read_b128 v[140:143], v179 offset:54272
    v_mfma_f32_32x32x16_bf16 v[32:47], v[84:87], v[100:103], v[32:47]
    ds_read_b128 v[148:151], v179 offset:55296
    ds_read_b128 v[156:159], v179 offset:56320
    v_mfma_f32_32x32x16_bf16 v[48:63], v[84:87], v[108:111], v[48:63]
    v_mfma_f32_32x32x16_bf16 v[64:79], v[116:119], v[84:87], v[64:79]
    v_mfma_f32_32x32x16_bf16 v[16:31], v[92:95], v[84:87], v[16:31]
    s_waitcnt lgkmcnt(0)
    s_barrier
    v_mfma_f32_32x32x16_bf16 v[32:47], v[120:123], v[136:139], v[32:47]
    ds_read_b128 v[80:83], v178 offset:0
    ds_read_b128 v[88:91], v180 offset:0
    v_mfma_f32_32x32x16_bf16 v[48:63], v[120:123], v[144:147], v[48:63]
    ds_read_b128 v[96:99], v180 offset:1024
    ds_read_b128 v[104:107], v180 offset:2048
    v_mfma_f32_32x32x16_bf16 v[64:79], v[152:155], v[120:123], v[64:79]
    ds_read_b128 v[112:115], v180 offset:3072
    ds_read_b128 v[84:87], v178 offset:1024
    v_mfma_f32_32x32x16_bf16 v[16:31], v[128:131], v[120:123], v[16:31]
    ds_read_b128 v[92:95], v180 offset:4096
    ds_read_b128 v[100:103], v180 offset:5120
    v_mfma_f32_32x32x16_bf16 v[32:47], v[124:127], v[140:143], v[32:47]
    ds_read_b128 v[108:111], v180 offset:6144
    ds_read_b128 v[116:119], v180 offset:7168
    v_mfma_f32_32x32x16_bf16 v[48:63], v[124:127], v[148:151], v[48:63]
    ds_read_b64 v[192:193], v7
    ds_read_b64 v[184:185], v14 offset:0
    v_mfma_f32_32x32x16_bf16 v[64:79], v[156:159], v[124:127], v[64:79]
    ds_read_b64 v[186:187], v14 offset:512
    ds_read_b64 v[188:189], v14 offset:1024
    v_mfma_f32_32x32x16_bf16 v[16:31], v[132:135], v[124:127], v[16:31]
    ds_read_b64 v[190:191], v14 offset:1536
    s_waitcnt lgkmcnt(0)
    s_barrier
    v_mfma_f32_32x32x8bf16_1k v[16:31], v[184:185], v[192:193], v[16:31]
    ds_read_b128 v[120:123], v178 offset:16384
    ds_read_b128 v[128:131], v180 offset:16384
    v_mfma_f32_32x32x8bf16_1k v[32:47], v[192:193], v[186:187], v[32:47]
    ds_read_b128 v[136:139], v180 offset:17408
    ds_read_b128 v[144:147], v180 offset:18432
    v_mfma_f32_32x32x8bf16_1k v[48:63], v[192:193], v[188:189], v[48:63]
    ds_read_b128 v[152:155], v180 offset:19456
    ds_read_b128 v[124:127], v178 offset:17408
    v_mfma_f32_32x32x8bf16_1k v[64:79], v[190:191], v[192:193], v[64:79]
    ds_read_b128 v[132:135], v180 offset:20480
    ds_read_b128 v[140:143], v180 offset:21504
    v_mfma_f32_32x32x16_bf16 v[32:47], v[80:83], v[96:99], v[32:47]
    ds_read_b128 v[148:151], v180 offset:22528
    ds_read_b128 v[156:159], v180 offset:23552
    v_mfma_f32_32x32x16_bf16 v[48:63], v[80:83], v[104:107], v[48:63]
    v_mfma_f32_32x32x16_bf16 v[64:79], v[112:115], v[80:83], v[64:79]
    v_mfma_f32_32x32x16_bf16 v[16:31], v[88:91], v[80:83], v[16:31]
    v_mfma_f32_32x32x16_bf16 v[32:47], v[84:87], v[100:103], v[32:47]
    v_mfma_f32_32x32x16_bf16 v[48:63], v[84:87], v[108:111], v[48:63]
    v_mfma_f32_32x32x16_bf16 v[64:79], v[116:119], v[84:87], v[64:79]
    v_mfma_f32_32x32x16_bf16 v[16:31], v[92:95], v[84:87], v[16:31]
    s_waitcnt lgkmcnt(0)
    s_barrier
    v_mfma_f32_32x32x16_bf16 v[32:47], v[120:123], v[136:139], v[32:47]
    ds_read_b128 v[80:83], v178 offset:32768
    ds_read_b128 v[88:91], v180 offset:32768
    v_mfma_f32_32x32x16_bf16 v[48:63], v[120:123], v[144:147], v[48:63]
    ds_read_b128 v[96:99], v180 offset:33792
    ds_read_b128 v[104:107], v180 offset:34816
    v_mfma_f32_32x32x16_bf16 v[64:79], v[152:155], v[120:123], v[64:79]
    ds_read_b128 v[112:115], v180 offset:35840
    ds_read_b128 v[84:87], v178 offset:33792
    v_mfma_f32_32x32x16_bf16 v[16:31], v[128:131], v[120:123], v[16:31]
    ds_read_b128 v[92:95], v180 offset:36864
    ds_read_b128 v[100:103], v180 offset:37888
    v_mfma_f32_32x32x16_bf16 v[32:47], v[124:127], v[140:143], v[32:47]
    ds_read_b128 v[108:111], v180 offset:38912
    ds_read_b128 v[116:119], v180 offset:39936
    v_mfma_f32_32x32x16_bf16 v[48:63], v[124:127], v[148:151], v[48:63]
    ds_read_b64 v[194:195], v7 offset:1024
    v_mfma_f32_32x32x16_bf16 v[64:79], v[156:159], v[124:127], v[64:79]
    v_mfma_f32_32x32x16_bf16 v[16:31], v[132:135], v[124:127], v[16:31]
    s_waitcnt lgkmcnt(0)
    s_barrier
    v_mfma_f32_32x32x16_bf16 v[32:47], v[80:83], v[96:99], v[32:47]
    ds_read_b128 v[120:123], v178 offset:49152
    ds_read_b128 v[128:131], v180 offset:49152
    v_mfma_f32_32x32x16_bf16 v[48:63], v[80:83], v[104:107], v[48:63]
    ds_read_b128 v[136:139], v180 offset:50176
    ds_read_b128 v[144:147], v180 offset:51200
    v_mfma_f32_32x32x16_bf16 v[64:79], v[112:115], v[80:83], v[64:79]
    ds_read_b128 v[152:155], v180 offset:52224
    ds_read_b128 v[124:127], v178 offset:50176
    v_mfma_f32_32x32x16_bf16 v[16:31], v[88:91], v[80:83], v[16:31]
    ds_read_b128 v[132:135], v180 offset:53248
    ds_read_b128 v[140:143], v180 offset:54272
    v_mfma_f32_32x32x16_bf16 v[32:47], v[84:87], v[100:103], v[32:47]
    ds_read_b128 v[148:151], v180 offset:55296
    ds_read_b128 v[156:159], v180 offset:56320
    v_mfma_f32_32x32x16_bf16 v[48:63], v[84:87], v[108:111], v[48:63]
    ds_read_b128 v[160:163], v8 offset:0
    ds_read_b128 v[164:167], v8 offset:32
    v_mfma_f32_32x32x16_bf16 v[64:79], v[116:119], v[84:87], v[64:79]
    ds_read_b128 v[168:171], v8 offset:64
    ds_read_b128 v[172:175], v8 offset:96
    v_mfma_f32_32x32x16_bf16 v[16:31], v[92:95], v[84:87], v[16:31]
    s_waitcnt lgkmcnt(0)
    s_barrier
    v_mfma_f32_32x32x16_bf16 v[32:47], v[120:123], v[136:139], v[32:47]
    ds_read_b128 v[80:83], v177 offset:0
    ds_read_b128 v[88:91], v179 offset:0
    v_mfma_f32_32x32x16_bf16 v[48:63], v[120:123], v[144:147], v[48:63]
    ds_read_b128 v[96:99], v179 offset:1024
    ds_read_b128 v[104:107], v179 offset:2048
    v_mfma_f32_32x32x16_bf16 v[64:79], v[152:155], v[120:123], v[64:79]
    ds_read_b128 v[112:115], v179 offset:3072
    ds_read_b128 v[84:87], v177 offset:1024
    v_mfma_f32_32x32x16_bf16 v[16:31], v[128:131], v[120:123], v[16:31]
    ds_read_b128 v[92:95], v179 offset:4096
    ds_read_b128 v[100:103], v179 offset:5120
    v_mfma_f32_32x32x16_bf16 v[32:47], v[124:127], v[140:143], v[32:47]
    ds_read_b128 v[108:111], v179 offset:6144
    ds_read_b128 v[116:119], v179 offset:7168
    v_mfma_f32_32x32x16_bf16 v[48:63], v[124:127], v[148:151], v[48:63]
    v_mfma_f32_32x32x16_bf16 v[64:79], v[156:159], v[124:127], v[64:79]
    v_mfma_f32_32x32x16_bf16 v[16:31], v[132:135], v[124:127], v[16:31]
    s_waitcnt lgkmcnt(0)
    s_barrier
    v_mfma_f32_32x32x16_bf16 v[32:47], v[80:83], v[96:99], v[32:47]
    ds_read_b128 v[120:123], v177 offset:16384
    ds_read_b128 v[128:131], v179 offset:16384
    v_mfma_f32_32x32x16_bf16 v[48:63], v[80:83], v[104:107], v[48:63]
    ds_read_b128 v[136:139], v179 offset:17408
    ds_read_b128 v[144:147], v179 offset:18432
    v_mfma_f32_32x32x16_bf16 v[64:79], v[112:115], v[80:83], v[64:79]
    ds_read_b128 v[152:155], v179 offset:19456
    ds_read_b128 v[124:127], v177 offset:17408
    v_mfma_f32_32x32x16_bf16 v[16:31], v[88:91], v[80:83], v[16:31]
    ds_read_b128 v[132:135], v179 offset:20480
    ds_read_b128 v[140:143], v179 offset:21504
    v_mfma_f32_32x32x16_bf16 v[32:47], v[84:87], v[100:103], v[32:47]
    ds_read_b128 v[148:151], v179 offset:22528
    ds_read_b128 v[156:159], v179 offset:23552
    v_mfma_f32_32x32x16_bf16 v[48:63], v[84:87], v[108:111], v[48:63]
    v_mfma_f32_32x32x16_bf16 v[64:79], v[116:119], v[84:87], v[64:79]
    v_mfma_f32_32x32x16_bf16 v[16:31], v[92:95], v[84:87], v[16:31]
    s_waitcnt lgkmcnt(0)
    v_mfma_f32_32x32x16_bf16 v[32:47], v[120:123], v[136:139], v[32:47]
    v_mfma_f32_32x32x16_bf16 v[48:63], v[120:123], v[144:147], v[48:63]
    v_mfma_f32_32x32x16_bf16 v[32:47], v[124:127], v[140:143], v[32:47]
    v_mfma_f32_32x32x16_bf16 v[64:79], v[152:155], v[120:123], v[64:79]
    v_mfma_f32_32x32x16_bf16 v[48:63], v[124:127], v[148:151], v[48:63]
    v_mfma_f32_32x32x16_bf16 v[16:31], v[128:131], v[120:123], v[16:31]
    v_mfma_f32_32x32x16_bf16 v[64:79], v[156:159], v[124:127], v[64:79]
    v_mfma_f32_32x32x16_bf16 v[16:31], v[132:135], v[124:127], v[16:31]
    s_nop 6
    v_pk_fma_f32 v[32:33], v[32:33], v[160:161], v[198:199]
    v_pk_fma_f32 v[34:35], v[34:35], v[162:163], v[198:199]
    v_pk_fma_f32 v[36:37], v[36:37], v[164:165], v[198:199]
    v_pk_fma_f32 v[38:39], v[38:39], v[166:167], v[198:199]
    v_pk_fma_f32 v[120:121], v[32:33], v[200:201], v[202:203]
    v_pk_fma_f32 v[122:123], v[34:35], v[200:201], v[202:203]
    v_pk_fma_f32 v[124:125], v[36:37], v[200:201], v[202:203]
    v_pk_fma_f32 v[126:127], v[38:39], v[200:201], v[202:203]
    v_exp_f32_e64 v120, v120 clamp
    v_max_f32 v32, v198, v32
    v_exp_f32_e64 v121, v121 clamp
    v_max_f32 v33, v198, v33
    v_exp_f32_e64 v122, v122 clamp
    v_max_f32 v34, v198, v34
    v_exp_f32_e64 v123, v123 clamp
    v_max_f32 v35, v198, v35
    v_exp_f32_e64 v124, v124 clamp
    v_max_f32 v36, v198, v36
    v_exp_f32_e64 v125, v125 clamp
    v_max_f32 v37, v198, v37
    v_exp_f32_e64 v126, v126 clamp
    v_max_f32 v38, v198, v38
    v_exp_f32_e64 v127, v127 clamp
    v_max_f32 v39, v198, v39
    v_pk_add_f32 v[32:33], v[32:33], v[120:121]
    v_pk_add_f32 v[34:35], v[34:35], v[122:123]
    v_pk_add_f32 v[36:37], v[36:37], v[124:125]
    v_pk_add_f32 v[38:39], v[38:39], v[126:127]
    v_cvt_pk_bf16_f32 v88, v32, v33
    v_cvt_pk_bf16_f32 v89, v34, v35
    v_cvt_pk_bf16_f32 v90, v36, v37
    v_cvt_pk_bf16_f32 v91, v38, v39
    ds_write_b128 v206, v[88:91] offset:0
    v_pk_fma_f32 v[40:41], v[40:41], v[168:169], v[198:199]
    v_pk_fma_f32 v[42:43], v[42:43], v[170:171], v[198:199]
    v_pk_fma_f32 v[44:45], v[44:45], v[172:173], v[198:199]
    v_pk_fma_f32 v[46:47], v[46:47], v[174:175], v[198:199]
    v_pk_fma_f32 v[128:129], v[40:41], v[200:201], v[202:203]
    v_pk_fma_f32 v[130:131], v[42:43], v[200:201], v[202:203]
    v_pk_fma_f32 v[132:133], v[44:45], v[200:201], v[202:203]
    v_pk_fma_f32 v[134:135], v[46:47], v[200:201], v[202:203]
    v_exp_f32_e64 v128, v128 clamp
    v_max_f32 v40, v198, v40
    v_exp_f32_e64 v129, v129 clamp
    v_max_f32 v41, v198, v41
    v_exp_f32_e64 v130, v130 clamp
    v_max_f32 v42, v198, v42
    v_exp_f32_e64 v131, v131 clamp
    v_max_f32 v43, v198, v43
    v_exp_f32_e64 v132, v132 clamp
    v_max_f32 v44, v198, v44
    v_exp_f32_e64 v133, v133 clamp
    v_max_f32 v45, v198, v45
    v_exp_f32_e64 v134, v134 clamp
    v_max_f32 v46, v198, v46
    v_exp_f32_e64 v135, v135 clamp
    v_max_f32 v47, v198, v47
    v_pk_add_f32 v[40:41], v[40:41], v[128:129]
    v_pk_add_f32 v[42:43], v[42:43], v[130:131]
    v_pk_add_f32 v[44:45], v[44:45], v[132:133]
    v_pk_add_f32 v[46:47], v[46:47], v[134:135]
    v_cvt_pk_bf16_f32 v92, v40, v41
    v_cvt_pk_bf16_f32 v93, v42, v43
    v_cvt_pk_bf16_f32 v94, v44, v45
    v_cvt_pk_bf16_f32 v95, v46, v47
    ds_write_b128 v206, v[92:95] offset:2560
    v_pk_mul_f32 v[48:49], v[48:49], v[160:161]
    v_pk_mul_f32 v[50:51], v[50:51], v[162:163]
    v_pk_mul_f32 v[52:53], v[52:53], v[164:165]
    v_pk_mul_f32 v[54:55], v[54:55], v[166:167]
    v_cvt_pk_bf16_f32 v96, v48, v49
    v_cvt_pk_bf16_f32 v97, v50, v51
    v_cvt_pk_bf16_f32 v98, v52, v53
    v_cvt_pk_bf16_f32 v99, v54, v55
    ds_write_b128 v206, v[96:99] offset:1024
    v_pk_mul_f32 v[56:57], v[56:57], v[168:169]
    v_pk_mul_f32 v[58:59], v[58:59], v[170:171]
    v_pk_mul_f32 v[60:61], v[60:61], v[172:173]
    v_pk_mul_f32 v[62:63], v[62:63], v[174:175]
    v_cvt_pk_bf16_f32 v100, v56, v57
    v_cvt_pk_bf16_f32 v101, v58, v59
    v_cvt_pk_bf16_f32 v102, v60, v61
    v_cvt_pk_bf16_f32 v103, v62, v63
    ds_write_b128 v206, v[100:103] offset:3584
    v_pk_fma_f32 v[66:67], v[66:67], v[194:195], v[198:199]
    v_pk_fma_f32 v[64:65], v[64:65], v[194:195], v[198:199]
    v_pk_fma_f32 v[120:121], v[66:67], v[200:201], v[202:203]
    v_pk_fma_f32 v[122:123], v[64:65], v[200:201], v[202:203]
    v_exp_f32_e64 v120, v120 clamp
    v_max_f32 v66, v198, v66
    v_exp_f32_e64 v121, v121 clamp
    v_max_f32 v67, v198, v67
    v_exp_f32_e64 v122, v122 clamp
    v_max_f32 v64, v198, v64
    v_exp_f32_e64 v123, v123 clamp
    v_max_f32 v65, v198, v65
    v_pk_add_f32 v[66:67], v[66:67], v[120:121]
    v_pk_add_f32 v[64:65], v[64:65], v[122:123]
    v_pk_mul_f32 v[68:69], v[68:69], v[194:195]
    v_cvt_pk_bf16_f32 v105, v66, v67
    v_cvt_pk_bf16_f32 v106, v68, v69
    v_cvt_pk_bf16_f32 v104, v64, v65
    ds_write_b16 v209, v105 offset:2048
    ds_write_b16_d16_hi v209, v105 offset:2064
    ds_write_b16 v209, v106 offset:2080
    ds_write_b16_d16_hi v209, v106 offset:2096
    buffer_store_dword v104, v205, s[16:19], s44 offen offset:1024
    s_waitcnt lgkmcnt(0)
    s_barrier
    v_pk_fma_f32 v[16:17], v[16:17], v[194:195], v[198:199]
    v_pk_fma_f32 v[18:19], v[18:19], v[194:195], v[198:199]
    v_pk_fma_f32 v[20:21], v[20:21], v[194:195], v[198:199]
    v_pk_fma_f32 v[22:23], v[22:23], v[194:195], v[198:199]
    v_pk_fma_f32 v[120:121], v[16:17], v[200:201], v[202:203]
    v_pk_fma_f32 v[122:123], v[18:19], v[200:201], v[202:203]
    v_pk_fma_f32 v[124:125], v[20:21], v[200:201], v[202:203]
    v_pk_fma_f32 v[126:127], v[22:23], v[200:201], v[202:203]
    v_exp_f32_e64 v120, v120 clamp
    v_max_f32 v16, v198, v16
    v_exp_f32_e64 v121, v121 clamp
    v_max_f32 v17, v198, v17
    v_exp_f32_e64 v122, v122 clamp
    v_max_f32 v18, v198, v18
    v_exp_f32_e64 v123, v123 clamp
    v_max_f32 v19, v198, v19
    v_exp_f32_e64 v124, v124 clamp
    v_max_f32 v20, v198, v20
    v_exp_f32_e64 v125, v125 clamp
    v_max_f32 v21, v198, v21
    v_exp_f32_e64 v126, v126 clamp
    v_max_f32 v22, v198, v22
    v_exp_f32_e64 v127, v127 clamp
    v_max_f32 v23, v198, v23
    v_pk_add_f32 v[16:17], v[16:17], v[120:121]
    v_pk_add_f32 v[18:19], v[18:19], v[122:123]
    v_pk_add_f32 v[20:21], v[20:21], v[124:125]
    v_pk_add_f32 v[22:23], v[22:23], v[126:127]
    v_cvt_pk_bf16_f32 v80, v16, v17
    v_cvt_pk_bf16_f32 v81, v18, v19
    v_cvt_pk_bf16_f32 v82, v20, v21
    v_cvt_pk_bf16_f32 v83, v22, v23
    buffer_store_dwordx4 v[80:83], v204, s[16:19], s44 offen offset:0 sc1
    v_pk_fma_f32 v[24:25], v[24:25], v[194:195], v[198:199]
    v_pk_fma_f32 v[26:27], v[26:27], v[194:195], v[198:199]
    v_pk_fma_f32 v[28:29], v[28:29], v[194:195], v[198:199]
    v_pk_fma_f32 v[30:31], v[30:31], v[194:195], v[198:199]
    v_pk_fma_f32 v[128:129], v[24:25], v[200:201], v[202:203]
    v_pk_fma_f32 v[130:131], v[26:27], v[200:201], v[202:203]
    v_pk_fma_f32 v[132:133], v[28:29], v[200:201], v[202:203]
    v_pk_fma_f32 v[134:135], v[30:31], v[200:201], v[202:203]
    v_exp_f32_e64 v128, v128 clamp
    v_max_f32 v24, v198, v24
    v_exp_f32_e64 v129, v129 clamp
    v_max_f32 v25, v198, v25
    v_exp_f32_e64 v130, v130 clamp
    v_max_f32 v26, v198, v26
    v_exp_f32_e64 v131, v131 clamp
    v_max_f32 v27, v198, v27
    v_exp_f32_e64 v132, v132 clamp
    v_max_f32 v28, v198, v28
    v_exp_f32_e64 v133, v133 clamp
    v_max_f32 v29, v198, v29
    v_exp_f32_e64 v134, v134 clamp
    v_max_f32 v30, v198, v30
    v_exp_f32_e64 v135, v135 clamp
    v_max_f32 v31, v198, v31
    v_pk_add_f32 v[24:25], v[24:25], v[128:129]
    v_pk_add_f32 v[26:27], v[26:27], v[130:131]
    v_pk_add_f32 v[28:29], v[28:29], v[132:133]
    v_pk_add_f32 v[30:31], v[30:31], v[134:135]
    v_cvt_pk_bf16_f32 v84, v24, v25
    v_cvt_pk_bf16_f32 v85, v26, v27
    v_cvt_pk_bf16_f32 v86, v28, v29
    v_cvt_pk_bf16_f32 v87, v30, v31
    buffer_store_dwordx4 v[84:87], v204, s[16:19], s44 offen offset:512 sc1
    s_branch L_L_qkvA_join1
L_L_qkvA_loader:
    s_and_b32 s36, s35, 1
    s_cmp_ge_u32 s35, 2
    s_cbranch_scc1 L_L_qkvA_helper
    s_lshl_b32 s52, s36, 12
    s_mul_i32 s53, s30, 147456
    s_add_u32 s53, s53, s52
    s_add_u32 s51, s52, 8192
    s_lshl_b32 s50, s31, 1
    s_add_u32 s50, s50, s36
    s_mul_i32 s50, s50, 73728
    s_add_u32 s55, s50, 36864
    v_cmp_gt_u32 vcc, 16, v5
    v_mov_b32 v7, 0x40000000
    s_nop 0
    v_cndmask_b32 v20, v7, v176, vcc
    s_waitcnt lgkmcnt(0)
    s_add_u32 s8, s4, s58
    s_addc_u32 s9, s5, 0
    s_mov_b32 s10, 2359296
    s_mov_b32 s11, 0x00020000
    s_add_u32 s12, s4, 0x2000000
    s_addc_u32 s13, s5, 0
    s_mov_b32 s14, 0x240000
    s_mov_b32 s15, 0x00020000
    s_add_u32 m0, s52, 0
    s_nop 0
    buffer_load_dwordx4 v176, s[8:11], s50 offen lds
    buffer_load_dwordx4 v176, s[8:11], s50 offen offset:1024 lds
    s_add_u32 m0, s52, 2048
    s_add_u32 s50, s50, 2048
    buffer_load_dwordx4 v176, s[8:11], s55 offen lds
    buffer_load_dwordx4 v176, s[8:11], s55 offen offset:1024 lds
    s_add_u32 s55, s55, 2048
    s_add_u32 m0, s51, 0
    s_nop 0
    buffer_load_dwordx4 v176, s[12:15], s53 offen offset:0 lds
    buffer_load_dwordx4 v176, s[12:15], s53 offen offset:1024 lds
    buffer_load_dwordx4 v176, s[12:15], s53 offen offset:2048 lds
    buffer_load_dwordx4 v20, s[12:15], s53 offen offset:3072 lds
    s_add_u32 s53, s53, 8192
    s_add_u32 m0, s52, 16384
    s_nop 0
    buffer_load_dwordx4 v176, s[8:11], s50 offen lds
    buffer_load_dwordx4 v176, s[8:11], s50 offen offset:1024 lds
    s_add_u32 m0, s52, 18432
    s_add_u32 s50, s50, 2048
    buffer_load_dwordx4 v176, s[8:11], s55 offen lds
    buffer_load_dwordx4 v176, s[8:11], s55 offen offset:1024 lds
    s_add_u32 s55, s55, 2048
    s_add_u32 m0, s51, 16384
    s_nop 0
    buffer_load_dwordx4 v176, s[12:15], s53 offen offset:0 lds
    buffer_load_dwordx4 v176, s[12:15], s53 offen offset:1024 lds
    buffer_load_dwordx4 v176, s[12:15], s53 offen offset:2048 lds
    buffer_load_dwordx4 v20, s[12:15], s53 offen offset:3072 lds
    s_add_u32 s53, s53, 8192
    s_add_u32 m0, s52, 32768
    s_nop 0
    buffer_load_dwordx4 v176, s[8:11], s50 offen lds
    buffer_load_dwordx4 v176, s[8:11], s50 offen offset:1024 lds
    s_add_u32 m0, s52, 34816
    s_add_u32 s50, s50, 2048
    buffer_load_dwordx4 v176, s[8:11], s55 offen lds
    buffer_load_dwordx4 v176, s[8:11], s55 offen offset:1024 lds
    s_add_u32 s55, s55, 2048
    s_add_u32 m0, s51, 32768
    s_nop 0
    buffer_load_dwordx4 v176, s[12:15], s53 offen offset:0 lds
    buffer_load_dwordx4 v176, s[12:15], s53 offen offset:1024 lds
    buffer_load_dwordx4 v176, s[12:15], s53 offen offset:2048 lds
    buffer_load_dwordx4 v20, s[12:15], s53 offen offset:3072 lds
    s_add_u32 s53, s53, 8192
    s_add_u32 m0, s52, 49152
    s_nop 0
    buffer_load_dwordx4 v176, s[8:11], s50 offen lds
    buffer_load_dwordx4 v176, s[8:11], s50 offen offset:1024 lds
    s_add_u32 m0, s52, 51200
    s_add_u32 s50, s50, 2048
    buffer_load_dwordx4 v176, s[8:11], s55 offen lds
    buffer_load_dwordx4 v176, s[8:11], s55 offen offset:1024 lds
    s_add_u32 s55, s55, 2048
    s_add_u32 m0, s51, 49152
    s_nop 0
    buffer_load_dwordx4 v176, s[12:15], s53 offen offset:0 lds
    buffer_load_dwordx4 v176, s[12:15], s53 offen offset:1024 lds
    buffer_load_dwordx4 v176, s[12:15], s53 offen offset:2048 lds
    buffer_load_dwordx4 v20, s[12:15], s53 offen offset:3072 lds
    s_add_u32 s53, s53, 8192
    s_waitcnt vmcnt(16)
    s_barrier
    s_add_u32 m0, s52, 65536
    s_nop 0
    buffer_load_dwordx4 v176, s[8:11], s50 offen lds
    buffer_load_dwordx4 v176, s[8:11], s50 offen offset:1024 lds
    s_add_u32 m0, s52, 67584
    s_add_u32 s50, s50, 2048
    buffer_load_dwordx4 v176, s[8:11], s55 offen lds
    buffer_load_dwordx4 v176, s[8:11], s55 offen offset:1024 lds
    s_add_u32 s55, s55, 2048
    s_add_u32 m0, s51, 65536
    s_nop 0
    buffer_load_dwordx4 v176, s[12:15], s53 offen offset:0 lds
    buffer_load_dwordx4 v176, s[12:15], s53 offen offset:1024 lds
    buffer_load_dwordx4 v176, s[12:15], s53 offen offset:2048 lds
    buffer_load_dwordx4 v20, s[12:15], s53 offen offset:3072 lds
    s_add_u32 s53, s53, 8192
    s_waitcnt vmcnt(16)
    s_barrier
    s_add_u32 m0, s52, 81920
    s_nop 0
    buffer_load_dwordx4 v176, s[8:11], s50 offen lds
    buffer_load_dwordx4 v176, s[8:11], s50 offen offset:1024 lds
    s_add_u32 m0, s52, 83968
    s_add_u32 s50, s50, 2048
    buffer_load_dwordx4 v176, s[8:11], s55 offen lds
    buffer_load_dwordx4 v176, s[8:11], s55 offen offset:1024 lds
    s_add_u32 s55, s55, 2048
    s_add_u32 m0, s51, 81920
    s_nop 0
    buffer_load_dwordx4 v176, s[12:15], s53 offen offset:0 lds
    buffer_load_dwordx4 v176, s[12:15], s53 offen offset:1024 lds
    buffer_load_dwordx4 v176, s[12:15], s53 offen offset:2048 lds
    buffer_load_dwordx4 v20, s[12:15], s53 offen offset:3072 lds
    s_add_u32 s53, s53, 8192
    s_waitcnt vmcnt(16)
    s_barrier
    s_add_u32 m0, s52, 98304
    s_nop 0
    buffer_load_dwordx4 v176, s[8:11], s50 offen lds
    buffer_load_dwordx4 v176, s[8:11], s50 offen offset:1024 lds
    s_add_u32 m0, s52, 100352
    s_add_u32 s50, s50, 2048
    buffer_load_dwordx4 v176, s[8:11], s55 offen lds
    buffer_load_dwordx4 v176, s[8:11], s55 offen offset:1024 lds
    s_add_u32 s55, s55, 2048
    s_add_u32 m0, s51, 98304
    s_nop 0
    buffer_load_dwordx4 v176, s[12:15], s53 offen offset:0 lds
    buffer_load_dwordx4 v176, s[12:15], s53 offen offset:1024 lds
    buffer_load_dwordx4 v176, s[12:15], s53 offen offset:2048 lds
    buffer_load_dwordx4 v20, s[12:15], s53 offen offset:3072 lds
    s_add_u32 s53, s53, 8192
    s_waitcnt vmcnt(16)
    s_barrier
    s_add_u32 m0, s52, 114688
    s_nop 0
    buffer_load_dwordx4 v176, s[8:11], s50 offen lds
    buffer_load_dwordx4 v176, s[8:11], s50 offen offset:1024 lds
    s_add_u32 m0, s52, 116736
    s_add_u32 s50, s50, 2048
    buffer_load_dwordx4 v176, s[8:11], s55 offen lds
    buffer_load_dwordx4 v176, s[8:11], s55 offen offset:1024 lds
    s_add_u32 s55, s55, 2048
    s_add_u32 m0, s51, 114688
    s_nop 0
    buffer_load_dwordx4 v176, s[12:15], s53 offen offset:0 lds
    buffer_load_dwordx4 v176, s[12:15], s53 offen offset:1024 lds
    buffer_load_dwordx4 v176, s[12:15], s53 offen offset:2048 lds
    buffer_load_dwordx4 v20, s[12:15], s53 offen offset:3072 lds
    s_add_u32 s53, s53, 8192
    s_waitcnt vmcnt(16)
    s_barrier
    s_add_u32 m0, s52, 0
    s_nop 0
    buffer_load_dwordx4 v176, s[8:11], s50 offen lds
    buffer_load_dwordx4 v176, s[8:11], s50 offen offset:1024 lds
    s_add_u32 m0, s52, 2048
    s_add_u32 s50, s50, 2048
    buffer_load_dwordx4 v176, s[8:11], s55 offen lds
    buffer_load_dwordx4 v176, s[8:11], s55 offen offset:1024 lds
    s_add_u32 s55, s55, 2048
    s_add_u32 m0, s51, 0
    s_nop 0
    buffer_load_dwordx4 v176, s[12:15], s53 offen offset:0 lds
    buffer_load_dwordx4 v176, s[12:15], s53 offen offset:1024 lds
    buffer_load_dwordx4 v176, s[12:15], s53 offen offset:2048 lds
    buffer_load_dwordx4 v20, s[12:15], s53 offen offset:3072 lds
    s_add_u32 s53, s53, 8192
    s_waitcnt vmcnt(16)
    s_barrier
    s_add_u32 m0, s52, 16384
    s_nop 0
    buffer_load_dwordx4 v176, s[8:11], s50 offen lds
    buffer_load_dwordx4 v176, s[8:11], s50 offen offset:1024 lds
    s_add_u32 m0, s52, 18432
    s_add_u32 s50, s50, 2048
    buffer_load_dwordx4 v176, s[8:11], s55 offen lds
    buffer_load_dwordx4 v176, s[8:11], s55 offen offset:1024 lds
    s_add_u32 s55, s55, 2048
    s_add_u32 m0, s51, 16384
    s_nop 0
    buffer_load_dwordx4 v176, s[12:15], s53 offen offset:0 lds
    buffer_load_dwordx4 v176, s[12:15], s53 offen offset:1024 lds
    buffer_load_dwordx4 v176, s[12:15], s53 offen offset:2048 lds
    buffer_load_dwordx4 v20, s[12:15], s53 offen offset:3072 lds
    s_add_u32 s53, s53, 8192
    s_waitcnt vmcnt(16)
    s_barrier
    s_add_u32 m0, s52, 32768
    s_nop 0
    buffer_load_dwordx4 v176, s[8:11], s50 offen lds
    buffer_load_dwordx4 v176, s[8:11], s50 offen offset:1024 lds
    s_add_u32 m0, s52, 34816
    s_add_u32 s50, s50, 2048
    buffer_load_dwordx4 v176, s[8:11], s55 offen lds
    buffer_load_dwordx4 v176, s[8:11], s55 offen offset:1024 lds
    s_add_u32 s55, s55, 2048
    s_add_u32 m0, s51, 32768
    s_nop 0
    buffer_load_dwordx4 v176, s[12:15], s53 offen offset:0 lds
    buffer_load_dwordx4 v176, s[12:15], s53 offen offset:1024 lds
    buffer_load_dwordx4 v176, s[12:15], s53 offen offset:2048 lds
    buffer_load_dwordx4 v20, s[12:15], s53 offen offset:3072 lds
    s_add_u32 s53, s53, 8192
    s_waitcnt vmcnt(16)
    s_barrier
    s_add_u32 m0, s52, 49152
    s_nop 0
    buffer_load_dwordx4 v176, s[8:11], s50 offen lds
    buffer_load_dwordx4 v176, s[8:11], s50 offen offset:1024 lds
    s_add_u32 m0, s52, 51200
    s_add_u32 s50, s50, 2048
    buffer_load_dwordx4 v176, s[8:11], s55 offen lds
    buffer_load_dwordx4 v176, s[8:11], s55 offen offset:1024 lds
    s_add_u32 s55, s55, 2048
    s_add_u32 m0, s51, 49152
    s_nop 0
    buffer_load_dwordx4 v176, s[12:15], s53 offen offset:0 lds
    buffer_load_dwordx4 v176, s[12:15], s53 offen offset:1024 lds
    buffer_load_dwordx4 v176, s[12:15], s53 offen offset:2048 lds
    buffer_load_dwordx4 v20, s[12:15], s53 offen offset:3072 lds
    s_add_u32 s53, s53, 8192
    s_waitcnt vmcnt(16)
    s_barrier
    s_add_u32 m0, s52, 65536
    s_nop 0
    buffer_load_dwordx4 v176, s[8:11], s50 offen lds
    buffer_load_dwordx4 v176, s[8:11], s50 offen offset:1024 lds
    s_add_u32 m0, s52, 67584
    s_add_u32 s50, s50, 2048
    buffer_load_dwordx4 v176, s[8:11], s55 offen lds
    buffer_load_dwordx4 v176, s[8:11], s55 offen offset:1024 lds
    s_add_u32 s55, s55, 2048
    s_add_u32 m0, s51, 65536
    s_nop 0
    buffer_load_dwordx4 v176, s[12:15], s53 offen offset:0 lds
    buffer_load_dwordx4 v176, s[12:15], s53 offen offset:1024 lds
    buffer_load_dwordx4 v176, s[12:15], s53 offen offset:2048 lds
    buffer_load_dwordx4 v20, s[12:15], s53 offen offset:3072 lds
    s_add_u32 s53, s53, 8192
    s_waitcnt vmcnt(16)
    s_barrier
    s_add_u32 m0, s52, 81920
    s_nop 0
    buffer_load_dwordx4 v176, s[8:11], s50 offen lds
    buffer_load_dwordx4 v176, s[8:11], s50 offen offset:1024 lds
    s_add_u32 m0, s52, 83968
    s_add_u32 s50, s50, 2048
    buffer_load_dwordx4 v176, s[8:11], s55 offen lds
    buffer_load_dwordx4 v176, s[8:11], s55 offen offset:1024 lds
    s_add_u32 s55, s55, 2048
    s_add_u32 m0, s51, 81920
    s_nop 0
    buffer_load_dwordx4 v176, s[12:15], s53 offen offset:0 lds
    buffer_load_dwordx4 v176, s[12:15], s53 offen offset:1024 lds
    buffer_load_dwordx4 v176, s[12:15], s53 offen offset:2048 lds
    buffer_load_dwordx4 v20, s[12:15], s53 offen offset:3072 lds
    s_add_u32 s53, s53, 8192
    s_waitcnt vmcnt(16)
    s_barrier
    s_add_u32 m0, s52, 98304
    s_nop 0
    buffer_load_dwordx4 v176, s[8:11], s50 offen lds
    buffer_load_dwordx4 v176, s[8:11], s50 offen offset:1024 lds
    s_add_u32 m0, s52, 100352
    s_add_u32 s50, s50, 2048
    buffer_load_dwordx4 v176, s[8:11], s55 offen lds
    buffer_load_dwordx4 v176, s[8:11], s55 offen offset:1024 lds
    s_add_u32 s55, s55, 2048
    s_add_u32 m0, s51, 98304
    s_nop 0
    buffer_load_dwordx4 v176, s[12:15], s53 offen offset:0 lds
    buffer_load_dwordx4 v176, s[12:15], s53 offen offset:1024 lds
    buffer_load_dwordx4 v176, s[12:15], s53 offen offset:2048 lds
    buffer_load_dwordx4 v20, s[12:15], s53 offen offset:3072 lds
    s_add_u32 s53, s53, 8192
    s_waitcnt vmcnt(16)
    s_barrier
    s_add_u32 m0, s52, 114688
    s_nop 0
    buffer_load_dwordx4 v176, s[8:11], s50 offen lds
    buffer_load_dwordx4 v176, s[8:11], s50 offen offset:1024 lds
    s_add_u32 m0, s52, 116736
    s_add_u32 s50, s50, 2048
    buffer_load_dwordx4 v176, s[8:11], s55 offen lds
    buffer_load_dwordx4 v176, s[8:11], s55 offen offset:1024 lds
    s_add_u32 s55, s55, 2048
    s_add_u32 m0, s51, 114688
    s_nop 0
    buffer_load_dwordx4 v176, s[12:15], s53 offen offset:0 lds
    buffer_load_dwordx4 v176, s[12:15], s53 offen offset:1024 lds
    buffer_load_dwordx4 v176, s[12:15], s53 offen offset:2048 lds
    buffer_load_dwordx4 v20, s[12:15], s53 offen offset:3072 lds
    s_add_u32 s53, s53, 8192
    s_waitcnt vmcnt(16)
    s_barrier
    s_add_u32 m0, s52, 0
    s_nop 0
    buffer_load_dwordx4 v176, s[8:11], s50 offen lds
    buffer_load_dwordx4 v176, s[8:11], s50 offen offset:1024 lds
    s_add_u32 m0, s52, 2048
    s_add_u32 s50, s50, 2048
    buffer_load_dwordx4 v176, s[8:11], s55 offen lds
    buffer_load_dwordx4 v176, s[8:11], s55 offen offset:1024 lds
    s_add_u32 s55, s55, 2048
    s_add_u32 m0, s51, 0
    s_nop 0
    buffer_load_dwordx4 v176, s[12:15], s53 offen offset:0 lds
    buffer_load_dwordx4 v176, s[12:15], s53 offen offset:1024 lds
    buffer_load_dwordx4 v176, s[12:15], s53 offen offset:2048 lds
    buffer_load_dwordx4 v20, s[12:15], s53 offen offset:3072 lds
    s_add_u32 s53, s53, 8192
    s_waitcnt vmcnt(16)
    s_barrier
    s_add_u32 m0, s52, 16384
    s_nop 0
    buffer_load_dwordx4 v176, s[8:11], s50 offen lds
    buffer_load_dwordx4 v176, s[8:11], s50 offen offset:1024 lds
    s_add_u32 m0, s52, 18432
    s_add_u32 s50, s50, 2048
    buffer_load_dwordx4 v176, s[8:11], s55 offen lds
    buffer_load_dwordx4 v176, s[8:11], s55 offen offset:1024 lds
    s_add_u32 s55, s55, 2048
    s_add_u32 m0, s51, 16384
    s_nop 0
    buffer_load_dwordx4 v176, s[12:15], s53 offen offset:0 lds
    buffer_load_dwordx4 v176, s[12:15], s53 offen offset:1024 lds
    buffer_load_dwordx4 v176, s[12:15], s53 offen offset:2048 lds
    buffer_load_dwordx4 v20, s[12:15], s53 offen offset:3072 lds
    s_add_u32 s53, s53, 8192
    s_waitcnt vmcnt(16)
    s_barrier
    s_waitcnt vmcnt(8)
    s_barrier
    s_waitcnt vmcnt(0)
    s_barrier
    s_endpgm
L_L_qkvA_helper:
    s_lshl_b32 s34, s31, 14
    s_add_u32 s57, s34, s57
    s_lshl_b32 s34, s36, 13
    s_add_u32 s57, s34, s57
    v_lshrrev_b32 v11, 3, v3
    v_and_b32 v12, 7, v3
    v_lshlrev_b32 v11, 10, v11
    v_lshl_add_u32 v11, v12, 4, v11
    s_lshl_b32 s54, s30, 9
    s_lshl_b32 s34, s36, 8
    s_add_u32 s54, s54, s34
    s_add_u32 s54, s54, 0x1480000
    v_lshlrev_b32 v7, 2, v5
    v_lshl_add_u32 v8, v6, 30, v7
    v_add_u32 v8, 16384, v8
    v_lshl_add_u32 v7, v6, 13, v7
    s_waitcnt lgkmcnt(0)
    s_mov_b32 s16, s4
    s_mov_b32 s17, s5
    s_mov_b32 s18, 0x8000000
    s_mov_b32 s19, 0x00020000
    buffer_load_dwordx4 v[128:131], v11, s[16:19], s57 offen offset:0
    buffer_load_dwordx4 v[132:135], v11, s[16:19], s57 offen offset:128
    buffer_load_dwordx4 v[136:139], v11, s[16:19], s57 offen offset:256
    buffer_load_dwordx4 v[140:143], v11, s[16:19], s57 offen offset:384
    buffer_load_dwordx4 v[144:147], v11, s[16:19], s57 offen offset:512
    buffer_load_dwordx4 v[148:151], v11, s[16:19], s57 offen offset:640
    buffer_load_dwordx4 v[152:155], v11, s[16:19], s57 offen offset:768
    buffer_load_dwordx4 v[156:159], v11, s[16:19], s57 offen offset:896
    buffer_load_dword v160, v7, s[16:19], s54 offen offset:0
    buffer_load_dword v164, v7, s[16:19], s54 offen offset:128
    s_add_u32 s54, s54, 16384
    buffer_load_dword v161, v7, s[16:19], s54 offen offset:0
    buffer_load_dword v165, v7, s[16:19], s54 offen offset:128
    s_add_u32 s54, s54, 16384
    buffer_load_dword v162, v7, s[16:19], s54 offen offset:0
    buffer_load_dword v166, v7, s[16:19], s54 offen offset:128
    s_add_u32 s54, s54, 16384
    s_barrier
    s_barrier
    s_waitcnt vmcnt(0)
    v_pk_add_f32 v[128:129], v[128:129], v[130:131]
    v_pk_add_f32 v[132:133], v[132:133], v[134:135]
    v_pk_add_f32 v[136:137], v[136:137], v[138:139]
    v_pk_add_f32 v[140:141], v[140:141], v[142:143]
    v_pk_add_f32 v[144:145], v[144:145], v[146:147]
    v_pk_add_f32 v[148:149], v[148:149], v[150:151]
    v_pk_add_f32 v[152:153], v[152:153], v[154:155]
    v_pk_add_f32 v[156:157], v[156:157], v[158:159]
    v_add_f32_dpp v130, v128, v128 quad_perm:[1,0,3,2] row_mask:0xf bank_mask:0xf
    v_add_f32_dpp v131, v129, v129 quad_perm:[1,0,3,2] row_mask:0xf bank_mask:0xf
    v_add_f32_dpp v134, v132, v132 quad_perm:[1,0,3,2] row_mask:0xf bank_mask:0xf
    v_add_f32_dpp v135, v133, v133 quad_perm:[1,0,3,2] row_mask:0xf bank_mask:0xf
    v_add_f32_dpp v138, v136, v136 quad_perm:[1,0,3,2] row_mask:0xf bank_mask:0xf
    s_barrier
    v_add_f32_dpp v139, v137, v137 quad_perm:[1,0,3,2] row_mask:0xf bank_mask:0xf
    v_add_f32_dpp v142, v140, v140 quad_perm:[1,0,3,2] row_mask:0xf bank_mask:0xf
    v_add_f32_dpp v143, v141, v141 quad_perm:[1,0,3,2] row_mask:0xf bank_mask:0xf
    v_add_f32_dpp v146, v144, v144 quad_perm:[1,0,3,2] row_mask:0xf bank_mask:0xf
    v_add_f32_dpp v147, v145, v145 quad_perm:[1,0,3,2] row_mask:0xf bank_mask:0xf
    v_add_f32_dpp v150, v148, v148 quad_perm:[1,0,3,2] row_mask:0xf bank_mask:0xf
    v_add_f32_dpp v151, v149, v149 quad_perm:[1,0,3,2] row_mask:0xf bank_mask:0xf
    v_add_f32_dpp v154, v152, v152 quad_perm:[1,0,3,2] row_mask:0xf bank_mask:0xf
    v_add_f32_dpp v155, v153, v153 quad_perm:[1,0,3,2] row_mask:0xf bank_mask:0xf
    v_add_f32_dpp v158, v156, v156 quad_perm:[1,0,3,2] row_mask:0xf bank_mask:0xf
    v_add_f32_dpp v159, v157, v157 quad_perm:[1,0,3,2] row_mask:0xf bank_mask:0xf
    v_add_f32_dpp v128, v130, v130 quad_perm:[2,3,0,1] row_mask:0xf bank_mask:0xf
    v_add_f32_dpp v129, v131, v131 quad_perm:[2,3,0,1] row_mask:0xf bank_mask:0xf
    v_add_f32_dpp v132, v134, v134 quad_perm:[2,3,0,1] row_mask:0xf bank_mask:0xf
    s_barrier
    v_add_f32_dpp v133, v135, v135 quad_perm:[2,3,0,1] row_mask:0xf bank_mask:0xf
    v_add_f32_dpp v136, v138, v138 quad_perm:[2,3,0,1] row_mask:0xf bank_mask:0xf
    v_add_f32_dpp v137, v139, v139 quad_perm:[2,3,0,1] row_mask:0xf bank_mask:0xf
    v_add_f32_dpp v140, v142, v142 quad_perm:[2,3,0,1] row_mask:0xf bank_mask:0xf
    v_add_f32_dpp v141, v143, v143 quad_perm:[2,3,0,1] row_mask:0xf bank_mask:0xf
    v_add_f32_dpp v144, v146, v146 quad_perm:[2,3,0,1] row_mask:0xf bank_mask:0xf
    v_add_f32_dpp v145, v147, v147 quad_perm:[2,3,0,1] row_mask:0xf bank_mask:0xf
    v_add_f32_dpp v148, v150, v150 quad_perm:[2,3,0,1] row_mask:0xf bank_mask:0xf
    v_add_f32_dpp v149, v151, v151 quad_perm:[2,3,0,1] row_mask:0xf bank_mask:0xf
    v_add_f32_dpp v152, v154, v154 quad_perm:[2,3,0,1] row_mask:0xf bank_mask:0xf
    v_add_f32_dpp v153, v155, v155 quad_perm:[2,3,0,1] row_mask:0xf bank_mask:0xf
    v_add_f32_dpp v156, v158, v158 quad_perm:[2,3,0,1] row_mask:0xf bank_mask:0xf
    v_add_f32_dpp v157, v159, v159 quad_perm:[2,3,0,1] row_mask:0xf bank_mask:0xf
    v_add_f32_dpp v130, v128, v128 row_half_mirror row_mask:0xf bank_mask:0xf
    s_barrier
    v_add_f32_dpp v131, v129, v129 row_half_mirror row_mask:0xf bank_mask:0xf
    v_add_f32_dpp v134, v132, v132 row_half_mirror row_mask:0xf bank_mask:0xf
    v_add_f32_dpp v135, v133, v133 row_half_mirror row_mask:0xf bank_mask:0xf
    v_add_f32_dpp v138, v136, v136 row_half_mirror row_mask:0xf bank_mask:0xf
    v_add_f32_dpp v139, v137, v137 row_half_mirror row_mask:0xf bank_mask:0xf
    v_add_f32_dpp v142, v140, v140 row_half_mirror row_mask:0xf bank_mask:0xf
    v_add_f32_dpp v143, v141, v141 row_half_mirror row_mask:0xf bank_mask:0xf
    v_add_f32_dpp v146, v144, v144 row_half_mirror row_mask:0xf bank_mask:0xf
    v_add_f32_dpp v147, v145, v145 row_half_mirror row_mask:0xf bank_mask:0xf
    v_add_f32_dpp v150, v148, v148 row_half_mirror row_mask:0xf bank_mask:0xf
    v_add_f32_dpp v151, v149, v149 row_half_mirror row_mask:0xf bank_mask:0xf
    v_add_f32_dpp v154, v152, v152 row_half_mirror row_mask:0xf bank_mask:0xf
    v_add_f32_dpp v155, v153, v153 row_half_mirror row_mask:0xf bank_mask:0xf
    v_add_f32_dpp v158, v156, v156 row_half_mirror row_mask:0xf bank_mask:0xf
    s_barrier
    v_add_f32_dpp v159, v157, v157 row_half_mirror row_mask:0xf bank_mask:0xf
    v_and_b32 v9, 7, v3
    v_cmp_eq_u32 vcc, 1, v9
    s_nop 1
    v_cndmask_b32 v130, v130, v134, vcc
    v_cndmask_b32 v131, v131, v135, vcc
    v_cmp_eq_u32 vcc, 2, v9
    s_nop 1
    v_cndmask_b32 v130, v130, v138, vcc
    v_cndmask_b32 v131, v131, v139, vcc
    v_cmp_eq_u32 vcc, 3, v9
    s_nop 1
    v_cndmask_b32 v130, v130, v142, vcc
    v_cndmask_b32 v131, v131, v143, vcc
    s_barrier
    v_cmp_eq_u32 vcc, 4, v9
    s_nop 1
    v_cndmask_b32 v130, v130, v146, vcc
    v_cndmask_b32 v131, v131, v147, vcc
    v_cmp_eq_u32 vcc, 5, v9
    s_nop 1
    v_cndmask_b32 v130, v130, v150, vcc
    v_cndmask_b32 v131, v131, v151, vcc
    v_cmp_eq_u32 vcc, 6, v9
    s_nop 1
    v_cndmask_b32 v130, v130, v154, vcc
    v_cndmask_b32 v131, v131, v155, vcc
    v_cmp_eq_u32 vcc, 7, v9
    s_nop 1
    v_cndmask_b32 v130, v130, v158, vcc
    v_cndmask_b32 v131, v131, v159, vcc
    s_barrier
    v_mul_f32 v128, 0xbae38e39, v130
    v_mul_f32 v129, 0x3ae38e39, v131
    v_fma_f32 v129, -v128, v128, v129
    v_cvt_pk_bf16_f32 v130, v128, v128
    v_max_f32 v129, 0, v129
    v_and_b32 v130, 0xffff0000, v130
    v_add_f32 v129, 0x3727c5ac, v129
    v_sub_f32 v130, v128, v130
    v_rsq_f32 v132, v129
    v_cvt_pk_bf16_f32 v130, v128, v130
    v_mov_b32 v133, v132
    v_mov_b32 v131, v130
    s_lshl_b32 s34, s36, 6
    v_add_u32 v10, s34, v3
    s_barrier
    v_lshlrev_b32 v11, 3, v10
    v_lshlrev_b32 v10, 2, v10
    v_add_u32 v11, 134144, v11
    v_add_u32 v10, 136192, v10
    ds_write_b64 v11, v[130:131]
    ds_write_b64 v11, v[132:133] offset:1024
    ds_write_b32 v10, v132
    s_lshl_b32 s34, s36, 10
    s_add_u32 s34, s34, 136704
    v_lshl_add_u32 v10, v3, 3, s34
    v_add_f32 v160, v160, v161
    v_add_f32 v160, v160, v162
    v_cvt_pk_bf16_f32 v162, v160, v160
    v_and_b32 v9, 0xffff0000, v162
    s_barrier
    v_sub_f32 v9, v160, v9
    v_cvt_pk_bf16_f32 v163, v9, v9
    ds_write_b64 v10, v[162:163] offset:0
    v_add_f32 v164, v164, v165
    v_add_f32 v164, v164, v166
    v_cvt_pk_bf16_f32 v166, v164, v164
    v_and_b32 v9, 0xffff0000, v166
    v_sub_f32 v9, v164, v9
    v_cvt_pk_bf16_f32 v167, v9, v9
    ds_write_b64 v10, v[166:167] offset:512
    s_waitcnt lgkmcnt(0)
    s_barrier
    s_barrier
    v_subrev_u32 v0, 128, v0
    s_getpc_b64 s[20:21]
L_L_qkvA_pc2:
    s_sub_u32 s20, s20, L_L_qkvA_pc2-L_text_start
    s_subb_u32 s21, s21, 0
    s_mov_b32 s22, L_text_end-L_text_start
    s_mov_b32 s23, 0x00020000
    s_cmp_lt_u32 s2, 16
    s_cselect_b32 s34, 0, 0x40000000
    v_lshl_add_u32 v23, v0, 7, s34
    v_add_u32 v0, 128, v0
    s_barrier
    s_and_b32 s33, s35, 1
    s_lshl_b32 s34, s33, 8
    s_add_u32 s34, s34, 32768
    v_lshlrev_b32 v7, 9, v6
    v_lshl_add_u32 v7, v5, 4, v7
    v_add_u32 v7, s34, v7
    s_lshl_b32 s34, s33, 6
    s_add_u32 s34, s34, 34560
    v_lshlrev_b32 v8, 8, v6
    v_lshl_add_u32 v8, v5, 4, v8
    v_add_u32 v8, s34, v8
    v_cmp_gt_u32 vcc, 16, v5
    v_add_u32 v9, 32, v8
    v_add_u32 v12, 1024, v7
    v_cndmask_b32 v24, v8, v7, vcc
    v_cndmask_b32 v25, v9, v12, vcc
    v_cmp_gt_u32 s[48:49], 18, v5
    s_barrier
    v_mov_b32 v32, 0x3f803f80
    v_mov_b32 v33, 0x3f803f80
    v_mov_b32 v34, 0x3f803f80
    v_mov_b32 v35, 0x3f803f80
    v_mov_b32 v36, 0x3f803f80
    v_mov_b32 v37, 0x3f803f80
    v_mov_b32 v38, 0x3f803f80
    v_mov_b32 v39, 0x3f803f80
    v_mov_b32 v40, 0x3f803f80
    v_mov_b32 v41, 0x3f803f80
    v_mov_b32 v42, 0x3f803f80
    v_mov_b32 v43, 0x3f803f80
    v_mov_b32 v44, 0x3f803f80
    v_mov_b32 v45, 0x3f803f80
    v_mov_b32 v46, 0x3f803f80
    v_mov_b32 v47, 0x3f803f80
    v_mov_b32 v48, 0x3f803f80
    v_mov_b32 v49, 0x3f803f80
    v_mov_b32 v50, 0x3f803f80
    v_mov_b32 v51, 0x3f803f80
    v_mov_b32 v52, 0x3f803f80
    v_mov_b32 v53, 0x3f803f80
    v_mov_b32 v54, 0x3f803f80
    v_mov_b32 v55, 0x3f803f80
    v_mov_b32 v56, 0x3f803f80
    v_mov_b32 v57, 0x3f803f80
    v_mov_b32 v58, 0x3f803f80
    v_mov_b32 v59, 0x3f803f80
    v_mov_b32 v60, 0x3f803f80
    v_mov_b32 v61, 0x3f803f80
    v_mov_b32 v62, 0x3f803f80
    v_mov_b32 v63, 0x3f803f80
    s_barrier
    s_add_u32 s39, s43, s33
    s_mul_i32 s39, s39, 1408
    s_add_u32 s39, s39, s59
    s_mul_i32 s34, s33, 1536
    s_add_u32 s34, s34, 65536
    v_mul_u32_u24 v7, 288, v6
    v_lshl_add_u32 v7, v5, 2, v7
    v_add_u32 v7, s34, v7
    v_mov_b32 v9, 69632
    v_lshlrev_b32 v10, 2, v3
    v_add_u32 v11, s34, v10
    v_cndmask_b32 v7, v9, v7, s[48:49]
    v_cmp_eq_u32 vcc, 0, v6
    v_mov_b32 v12, 0x40000000
    s_nop 0
    v_cndmask_b32 v8, v9, v7, vcc
    v_cmp_gt_u32 vcc, 22, v3
    s_nop 1
    v_cndmask_b32 v12, v12, v10, vcc
    s_barrier
    buffer_load_dword v26, v23, s[20:23], 0 offen
    v_add_u32 v23, 16384, v23
    buffer_load_dword v26, v23, s[20:23], 0 offen
    v_add_u32 v23, 16384, v23
    buffer_load_dword v26, v23, s[20:23], 0 offen
    v_add_u32 v23, 16384, v23
    buffer_load_dword v26, v23, s[20:23], 0 offen
    v_add_u32 v23, 16384, v23
    s_barrier
    s_barrier
    s_mov_b64 exec, s[48:49]
    ds_read_b128 v[32:35], v25 offset:0
    ds_read_b128 v[64:67], v24 offset:0
    ds_read_b128 v[36:39], v25 offset:2560
    ds_read_b128 v[68:71], v24 offset:2560
    ds_read_b128 v[40:43], v25 offset:5120
    ds_read_b128 v[72:75], v24 offset:5120
    ds_read_b128 v[44:47], v25 offset:7680
    ds_read_b128 v[76:79], v24 offset:7680
    ds_read_b128 v[48:51], v25 offset:10240
    ds_read_b128 v[80:83], v24 offset:10240
    ds_read_b128 v[52:55], v25 offset:12800
    ds_read_b128 v[84:87], v24 offset:12800
    ds_read_b128 v[56:59], v25 offset:15360
    ds_read_b128 v[88:91], v24 offset:15360
    ds_read_b128 v[60:63], v25 offset:17920
    ds_read_b128 v[92:95], v24 offset:17920
    s_mov_b64 exec, -1
    s_waitcnt lgkmcnt(14)
    v_mfma_f32_32x32x16_bf16 v[96:111], v[32:35], v[64:67], 0
    s_waitcnt lgkmcnt(12)
    v_mfma_f32_32x32x16_bf16 v[96:111], v[36:39], v[68:71], v[96:111]
    s_waitcnt lgkmcnt(10)
    v_mfma_f32_32x32x16_bf16 v[96:111], v[40:43], v[72:75], v[96:111]
    s_waitcnt lgkmcnt(8)
    v_mfma_f32_32x32x16_bf16 v[96:111], v[44:47], v[76:79], v[96:111]
    s_waitcnt lgkmcnt(6)
    v_mfma_f32_32x32x16_bf16 v[96:111], v[48:51], v[80:83], v[96:111]
    s_waitcnt lgkmcnt(4)
    v_mfma_f32_32x32x16_bf16 v[96:111], v[52:55], v[84:87], v[96:111]
    s_waitcnt lgkmcnt(2)
    v_mfma_f32_32x32x16_bf16 v[96:111], v[56:59], v[88:91], v[96:111]
    s_waitcnt lgkmcnt(0)
    v_mfma_f32_32x32x16_bf16 v[96:111], v[60:63], v[92:95], v[96:111]
    s_nop 7
    s_nop 3
    ds_write_b32 v7, v96 offset:0
    ds_write_b32 v7, v97 offset:72
    ds_write_b32 v7, v98 offset:144
    ds_write_b32 v7, v99 offset:216
    ds_write_b32 v7, v100 offset:576
    ds_write_b32 v7, v101 offset:648
    ds_write_b32 v7, v102 offset:720
    ds_write_b32 v7, v103 offset:792
    ds_write_b32 v8, v104 offset:1152
    ds_write_b32 v8, v105 offset:1224
    ds_write_b32 v8, v106 offset:1296
    ds_read_b32 v32, v11 offset:0
    ds_read_b32 v33, v11 offset:256
    ds_read_b32 v34, v11 offset:512
    ds_read_b32 v35, v11 offset:768
    ds_read_b32 v36, v11 offset:1024
    ds_read_b32 v37, v11 offset:1280
    s_waitcnt lgkmcnt(5)
    buffer_atomic_add_f32 v32, v10, s[16:19], s39 offen offset:0
    s_waitcnt lgkmcnt(4)
    buffer_atomic_add_f32 v33, v10, s[16:19], s39 offen offset:256
    s_waitcnt lgkmcnt(3)
    buffer_atomic_add_f32 v34, v10, s[16:19], s39 offen offset:512
    s_waitcnt lgkmcnt(2)
    buffer_atomic_add_f32 v35, v10, s[16:19], s39 offen offset:768
    s_waitcnt lgkmcnt(1)
    buffer_atomic_add_f32 v36, v10, s[16:19], s39 offen offset:1024
    s_waitcnt lgkmcnt(0)
    buffer_atomic_add_f32 v37, v12, s[16:19], s39 offen offset:1280
L_L_qkvA_join1:
    s_waitcnt vmcnt(0)
L_L_qkvA_end:
    s_endpgm
.globl qkv_b1_kernel
.p2align 8
.type qkv_b1_kernel,@function
qkv_b1_kernel:
    s_mov_b32 s58, 0x0
    s_mov_b32 s59, 0x0
    s_mov_b32 s57, 0x1540000
    s_mov_b32 s60, 0x1
    s_mov_b32 s61, 0x0
    s_branch L_qkvB
.globl qkv_b2_kernel
.p2align 8
.type qkv_b2_kernel,@function
qkv_b2_kernel:
    s_mov_b32 s58, 0x480000
    s_mov_b32 s59, 0x0
    s_mov_b32 s57, 0x15c0000
    s_mov_b32 s60, 0x0
    s_mov_b32 s61, 0x0
    s_branch L_qkvB
.p2align 8
L_qkvB:
    s_cmp_ge_u32 s2, 256
    s_cbranch_scc1 L_L_qkvB_end
    s_load_dwordx2 s[4:5], s[0:1], 64
L_L_qkvB_fused:
    v_lshrrev_b32 v4, 6, v0
    s_and_b32 s28, s2, 7
    s_lshr_b32 s29, s2, 3
    v_readfirstlane_b32 s35, v4
    s_lshr_b32 s31, s28, 1
    s_lshl_b32 s31, s31, 2
    s_lshr_b32 s32, s29, 3
    s_add_u32 s31, s31, s32
    s_and_b32 s30, s28, 1
    s_lshl_b32 s30, s30, 3
    s_and_b32 s32, s29, 7
    s_add_u32 s30, s30, s32
    v_and_b32 v3, 63, v0
    v_and_b32 v5, 31, v3
    v_lshrrev_b32 v6, 5, v3
    v_lshlrev_b32 v176, 4, v3
    s_lshl_b32 s43, s30, 1
    s_cmp_lt_u32 s35, 4
    s_cbranch_scc1 L_L_qkvB_loader
    s_sub_u32 s40, s35, 4
    s_lshl_b32 s34, s40, 11
    v_add_u32 v177, s34, v176
    v_add_u32 v178, 0x10000, v177
    v_add_u32 v179, 8192, v176
    v_add_u32 v180, 0x10000, v179
    s_lshl_b32 s38, s31, 2
    s_add_u32 s38, s38, s40
    s_mul_i32 s44, s43, 73728
    s_mul_i32 s39, s38, 1152
    s_add_u32 s44, s44, s39
    s_add_u32 s44, s44, 0xb40000
    s_mul_i32 s46, s43, 155648
    s_mul_i32 s39, s38, 2432
    s_add_u32 s46, s46, s39
    s_add_u32 s46, s46, 0xf40000
    v_mul_u32_u24 v7, 73728, v6
    v_lshl_add_u32 v204, v5, 4, v7
    v_lshl_add_u32 v205, v5, 2, v7
    v_and_b32 v9, 3, v5
    v_bfe_u32 v10, v5, 3, 1
    v_lshl_add_u32 v9, v10, 2, v9
    v_lshlrev_b32 v9, 1, v9
    v_bfe_u32 v10, v5, 2, 1
    v_lshrrev_b32 v11, 4, v5
    v_mul_u32_u24 v7, 155648, v6
    v_lshl_add_u32 v206, v5, 4, v7
    v_lshl_add_u32 v207, v5, 2, v7
    v_mul_u32_u24 v7, 155648, v11
    v_mul_u32_u24 v8, 320, v6
    v_and_b32 v12, 15, v5
    v_lshl_add_u32 v8, v12, 4, v8
    v_add_u32 v208, v7, v8
    v_lshl_add_u32 v9, v10, 6, v9
    v_lshl_add_u32 v9, v11, 7, v9
    v_lshl_add_u32 v9, v6, 8, v9
    s_lshl_b32 s34, s40, 9
    s_add_u32 s34, s34, 132096
    v_add_u32 v209, s34, v9
    v_lshl_add_u32 v198, v5, 4, s34
    v_lshl_add_u32 v7, v6, 30, v7
    v_bfe_u32 v8, v5, 3, 1
    v_mul_u32_u24 v8, 640, v8
    v_add_u32 v7, v7, v8
    v_mul_u32_u24 v8, 320, v10
    v_add_u32 v7, v7, v8
    v_and_b32 v8, 3, v5
    v_lshl_add_u32 v199, v8, 4, v7
    v_cmp_eq_u32 vcc, 3, v8
    v_mov_b32 v9, 0x3f803f80
    s_nop 0
    v_cndmask_b32_e64 v8, v9, 0, vcc
    v_mov_b32 v9, v8
    v_mov_b32 v10, v8
    v_mov_b32 v11, v8
    ds_write_b128 v198, v[8:11]
    v_lshlrev_b32 v14, 3, v3
    v_add_u32 v14, 136704, v14
    s_lshl_b32 s34, s40, 8
    s_add_u32 s34, s34, 134144
    v_lshl_add_u32 v7, v5, 3, s34
    s_lshl_b32 s34, s40, 7
    s_add_u32 s34, s34, 136192
    v_lshl_add_u32 v8, v6, 4, s34
    s_waitcnt lgkmcnt(0)
    s_mov_b32 s16, s4
    s_mov_b32 s17, s5
    s_mov_b32 s18, 0x8000000
    s_mov_b32 s19, 0x00020000
    s_barrier
    ds_read_b128 v[80:83], v177 offset:0
    ds_read_b128 v[88:91], v179 offset:0
    ds_read_b128 v[96:99], v179 offset:1024
    ds_read_b128 v[104:107], v179 offset:2048
    ds_read_b128 v[112:115], v179 offset:3072
    ds_read_b128 v[84:87], v177 offset:1024
    ds_read_b128 v[92:95], v179 offset:4096
    ds_read_b128 v[100:103], v179 offset:5120
    ds_read_b128 v[108:111], v179 offset:6144
    ds_read_b128 v[116:119], v179 offset:7168
    s_waitcnt lgkmcnt(0)
    v_mfma_f32_32x32x16_bf16 v[16:31], v[88:91], v[80:83], 0
    ds_read_b128 v[120:123], v177 offset:16384
    ds_read_b128 v[128:131], v179 offset:16384
    v_mfma_f32_32x32x16_bf16 v[32:47], v[96:99], v[80:83], 0
    ds_read_b128 v[136:139], v179 offset:17408
    ds_read_b128 v[144:147], v179 offset:18432
    v_mfma_f32_32x32x16_bf16 v[48:63], v[80:83], v[104:107], 0
    ds_read_b128 v[152:155], v179 offset:19456
    ds_read_b128 v[124:127], v177 offset:17408
    v_mfma_f32_32x32x16_bf16 v[64:79], v[112:115], v[80:83], 0
    ds_read_b128 v[132:135], v179 offset:20480
    ds_read_b128 v[140:143], v179 offset:21504
    v_mfma_f32_32x32x16_bf16 v[16:31], v[92:95], v[84:87], v[16:31]
    ds_read_b128 v[148:151], v179 offset:22528
    ds_read_b128 v[156:159], v179 offset:23552
    v_mfma_f32_32x32x16_bf16 v[32:47], v[100:103], v[84:87], v[32:47]
    v_mfma_f32_32x32x16_bf16 v[48:63], v[84:87], v[108:111], v[48:63]
    v_mfma_f32_32x32x16_bf16 v[64:79], v[116:119], v[84:87], v[64:79]
    s_waitcnt lgkmcnt(0)
    s_barrier
    v_mfma_f32_32x32x16_bf16 v[16:31], v[128:131], v[120:123], v[16:31]
    ds_read_b128 v[80:83], v177 offset:32768
    ds_read_b128 v[88:91], v179 offset:32768
    v_mfma_f32_32x32x16_bf16 v[32:47], v[136:139], v[120:123], v[32:47]
    ds_read_b128 v[96:99], v179 offset:33792
    ds_read_b128 v[104:107], v179 offset:34816
    v_mfma_f32_32x32x16_bf16 v[48:63], v[120:123], v[144:147], v[48:63]
    ds_read_b128 v[112:115], v179 offset:35840
    ds_read_b128 v[84:87], v177 offset:33792
    v_mfma_f32_32x32x16_bf16 v[64:79], v[152:155], v[120:123], v[64:79]
    ds_read_b128 v[92:95], v179 offset:36864
    ds_read_b128 v[100:103], v179 offset:37888
    v_mfma_f32_32x32x16_bf16 v[16:31], v[132:135], v[124:127], v[16:31]
    ds_read_b128 v[108:111], v179 offset:38912
    ds_read_b128 v[116:119], v179 offset:39936
    v_mfma_f32_32x32x16_bf16 v[32:47], v[140:143], v[124:127], v[32:47]
    v_mfma_f32_32x32x16_bf16 v[48:63], v[124:127], v[148:151], v[48:63]
    v_mfma_f32_32x32x16_bf16 v[64:79], v[156:159], v[124:127], v[64:79]
    s_waitcnt lgkmcnt(0)
    s_barrier
    v_mfma_f32_32x32x16_bf16 v[16:31], v[88:91], v[80:83], v[16:31]
    ds_read_b128 v[120:123], v177 offset:49152
    ds_read_b128 v[128:131], v179 offset:49152
    v_mfma_f32_32x32x16_bf16 v[32:47], v[96:99], v[80:83], v[32:47]
    ds_read_b128 v[136:139], v179 offset:50176
    ds_read_b128 v[144:147], v179 offset:51200
    v_mfma_f32_32x32x16_bf16 v[48:63], v[80:83], v[104:107], v[48:63]
    ds_read_b128 v[152:155], v179 offset:52224
    ds_read_b128 v[124:127], v177 offset:50176
    v_mfma_f32_32x32x16_bf16 v[64:79], v[112:115], v[80:83], v[64:79]
    ds_read_b128 v[132:135], v179 offset:53248
    ds_read_b128 v[140:143], v179 offset:54272
    v_mfma_f32_32x32x16_bf16 v[16:31], v[92:95], v[84:87], v[16:31]
    ds_read_b128 v[148:151], v179 offset:55296
    ds_read_b128 v[156:159], v179 offset:56320
    v_mfma_f32_32x32x16_bf16 v[32:47], v[100:103], v[84:87], v[32:47]
    v_mfma_f32_32x32x16_bf16 v[48:63], v[84:87], v[108:111], v[48:63]
    v_mfma_f32_32x32x16_bf16 v[64:79], v[116:119], v[84:87], v[64:79]
    s_waitcnt lgkmcnt(0)
    s_barrier
    v_mfma_f32_32x32x16_bf16 v[16:31], v[128:131], v[120:123], v[16:31]
    ds_read_b128 v[80:83], v178 offset:0
    ds_read_b128 v[88:91], v180 offset:0
    v_mfma_f32_32x32x16_bf16 v[32:47], v[136:139], v[120:123], v[32:47]
    ds_read_b128 v[96:99], v180 offset:1024
    ds_read_b128 v[104:107], v180 offset:2048
    v_mfma_f32_32x32x16_bf16 v[48:63], v[120:123], v[144:147], v[48:63]
    ds_read_b128 v[112:115], v180 offset:3072
    ds_read_b128 v[84:87], v178 offset:1024
    v_mfma_f32_32x32x16_bf16 v[64:79], v[152:155], v[120:123], v[64:79]
    ds_read_b128 v[92:95], v180 offset:4096
    ds_read_b128 v[100:103], v180 offset:5120
    v_mfma_f32_32x32x16_bf16 v[16:31], v[132:135], v[124:127], v[16:31]
    ds_read_b128 v[108:111], v180 offset:6144
    ds_read_b128 v[116:119], v180 offset:7168
    v_mfma_f32_32x32x16_bf16 v[32:47], v[140:143], v[124:127], v[32:47]
    v_mfma_f32_32x32x16_bf16 v[48:63], v[124:127], v[148:151], v[48:63]
    v_mfma_f32_32x32x16_bf16 v[64:79], v[156:159], v[124:127], v[64:79]
    s_waitcnt lgkmcnt(0)
    s_barrier
    v_mfma_f32_32x32x16_bf16 v[16:31], v[88:91], v[80:83], v[16:31]
    ds_read_b128 v[120:123], v178 offset:16384
    ds_read_b128 v[128:131], v180 offset:16384
    v_mfma_f32_32x32x16_bf16 v[32:47], v[96:99], v[80:83], v[32:47]
    ds_read_b128 v[136:139], v180 offset:17408
    ds_read_b128 v[144:147], v180 offset:18432
    v_mfma_f32_32x32x16_bf16 v[48:63], v[80:83], v[104:107], v[48:63]
    ds_read_b128 v[152:155], v180 offset:19456
    ds_read_b128 v[124:127], v178 offset:17408
    v_mfma_f32_32x32x16_bf16 v[64:79], v[112:115], v[80:83], v[64:79]
    ds_read_b128 v[132:135], v180 offset:20480
    ds_read_b128 v[140:143], v180 offset:21504
    v_mfma_f32_32x32x16_bf16 v[16:31], v[92:95], v[84:87], v[16:31]
    ds_read_b128 v[148:151], v180 offset:22528
    ds_read_b128 v[156:159], v180 offset:23552
    v_mfma_f32_32x32x16_bf16 v[32:47], v[100:103], v[84:87], v[32:47]
    v_mfma_f32_32x32x16_bf16 v[48:63], v[84:87], v[108:111], v[48:63]
    v_mfma_f32_32x32x16_bf16 v[64:79], v[116:119], v[84:87], v[64:79]
    s_waitcnt lgkmcnt(0)
    s_barrier
    v_mfma_f32_32x32x16_bf16 v[16:31], v[128:131], v[120:123], v[16:31]
    ds_read_b128 v[80:83], v178 offset:32768
    ds_read_b128 v[88:91], v180 offset:32768
    v_mfma_f32_32x32x16_bf16 v[32:47], v[136:139], v[120:123], v[32:47]
    ds_read_b128 v[96:99], v180 offset:33792
    ds_read_b128 v[104:107], v180 offset:34816
    v_mfma_f32_32x32x16_bf16 v[48:63], v[120:123], v[144:147], v[48:63]
    ds_read_b128 v[112:115], v180 offset:35840
    ds_read_b128 v[84:87], v178 offset:33792
    v_mfma_f32_32x32x16_bf16 v[64:79], v[152:155], v[120:123], v[64:79]
    ds_read_b128 v[92:95], v180 offset:36864
    ds_read_b128 v[100:103], v180 offset:37888
    v_mfma_f32_32x32x16_bf16 v[16:31], v[132:135], v[124:127], v[16:31]
    ds_read_b128 v[108:111], v180 offset:38912
    ds_read_b128 v[116:119], v180 offset:39936
    v_mfma_f32_32x32x16_bf16 v[32:47], v[140:143], v[124:127], v[32:47]
    v_mfma_f32_32x32x16_bf16 v[48:63], v[124:127], v[148:151], v[48:63]
    v_mfma_f32_32x32x16_bf16 v[64:79], v[156:159], v[124:127], v[64:79]
    s_waitcnt lgkmcnt(0)
    s_barrier
    v_mfma_f32_32x32x16_bf16 v[16:31], v[88:91], v[80:83], v[16:31]
    ds_read_b128 v[120:123], v178 offset:49152
    ds_read_b128 v[128:131], v180 offset:49152
    v_mfma_f32_32x32x16_bf16 v[32:47], v[96:99], v[80:83], v[32:47]
    ds_read_b128 v[136:139], v180 offset:50176
    ds_read_b128 v[144:147], v180 offset:51200
    v_mfma_f32_32x32x16_bf16 v[48:63], v[80:83], v[104:107], v[48:63]
    ds_read_b128 v[152:155], v180 offset:52224
    ds_read_b128 v[124:127], v178 offset:50176
    v_mfma_f32_32x32x16_bf16 v[64:79], v[112:115], v[80:83], v[64:79]
    ds_read_b128 v[132:135], v180 offset:53248
    ds_read_b128 v[140:143], v180 offset:54272
    v_mfma_f32_32x32x16_bf16 v[16:31], v[92:95], v[84:87], v[16:31]
    ds_read_b128 v[148:151], v180 offset:55296
    ds_read_b128 v[156:159], v180 offset:56320
    v_mfma_f32_32x32x16_bf16 v[32:47], v[100:103], v[84:87], v[32:47]
    v_mfma_f32_32x32x16_bf16 v[48:63], v[84:87], v[108:111], v[48:63]
    v_mfma_f32_32x32x16_bf16 v[64:79], v[116:119], v[84:87], v[64:79]
    s_waitcnt lgkmcnt(0)
    s_barrier
    v_mfma_f32_32x32x16_bf16 v[16:31], v[128:131], v[120:123], v[16:31]
    ds_read_b128 v[80:83], v177 offset:0
    ds_read_b128 v[88:91], v179 offset:0
    v_mfma_f32_32x32x16_bf16 v[32:47], v[136:139], v[120:123], v[32:47]
    ds_read_b128 v[96:99], v179 offset:1024
    ds_read_b128 v[104:107], v179 offset:2048
    v_mfma_f32_32x32x16_bf16 v[48:63], v[120:123], v[144:147], v[48:63]
    ds_read_b128 v[112:115], v179 offset:3072
    ds_read_b128 v[84:87], v177 offset:1024
    v_mfma_f32_32x32x16_bf16 v[64:79], v[152:155], v[120:123], v[64:79]
    ds_read_b128 v[92:95], v179 offset:4096
    ds_read_b128 v[100:103], v179 offset:5120
    v_mfma_f32_32x32x16_bf16 v[16:31], v[132:135], v[124:127], v[16:31]
    ds_read_b128 v[108:111], v179 offset:6144
    ds_read_b128 v[116:119], v179 offset:7168
    v_mfma_f32_32x32x16_bf16 v[32:47], v[140:143], v[124:127], v[32:47]
    v_mfma_f32_32x32x16_bf16 v[48:63], v[124:127], v[148:151], v[48:63]
    v_mfma_f32_32x32x16_bf16 v[64:79], v[156:159], v[124:127], v[64:79]
    s_waitcnt lgkmcnt(0)
    s_barrier
    v_mfma_f32_32x32x16_bf16 v[16:31], v[88:91], v[80:83], v[16:31]
    ds_read_b128 v[120:123], v177 offset:16384
    ds_read_b128 v[128:131], v179 offset:16384
    v_mfma_f32_32x32x16_bf16 v[32:47], v[96:99], v[80:83], v[32:47]
    ds_read_b128 v[136:139], v179 offset:17408
    ds_read_b128 v[144:147], v179 offset:18432
    v_mfma_f32_32x32x16_bf16 v[48:63], v[80:83], v[104:107], v[48:63]
    ds_read_b128 v[152:155], v179 offset:19456
    ds_read_b128 v[124:127], v177 offset:17408
    v_mfma_f32_32x32x16_bf16 v[64:79], v[112:115], v[80:83], v[64:79]
    ds_read_b128 v[132:135], v179 offset:20480
    ds_read_b128 v[140:143], v179 offset:21504
    v_mfma_f32_32x32x16_bf16 v[16:31], v[92:95], v[84:87], v[16:31]
    ds_read_b128 v[148:151], v179 offset:22528
    ds_read_b128 v[156:159], v179 offset:23552
    v_mfma_f32_32x32x16_bf16 v[32:47], v[100:103], v[84:87], v[32:47]
    v_mfma_f32_32x32x16_bf16 v[48:63], v[84:87], v[108:111], v[48:63]
    v_mfma_f32_32x32x16_bf16 v[64:79], v[116:119], v[84:87], v[64:79]
    s_waitcnt lgkmcnt(0)
    s_barrier
    v_mfma_f32_32x32x16_bf16 v[16:31], v[128:131], v[120:123], v[16:31]
    ds_read_b128 v[80:83], v177 offset:32768
    ds_read_b128 v[88:91], v179 offset:32768
    v_mfma_f32_32x32x16_bf16 v[32:47], v[136:139], v[120:123], v[32:47]
    ds_read_b128 v[96:99], v179 offset:33792
    ds_read_b128 v[104:107], v179 offset:34816
    v_mfma_f32_32x32x16_bf16 v[48:63], v[120:123], v[144:147], v[48:63]
    ds_read_b128 v[112:115], v179 offset:35840
    ds_read_b128 v[84:87], v177 offset:33792
    v_mfma_f32_32x32x16_bf16 v[64:79], v[152:155], v[120:123], v[64:79]
    ds_read_b128 v[92:95], v179 offset:36864
    ds_read_b128 v[100:103], v179 offset:37888
    v_mfma_f32_32x32x16_bf16 v[16:31], v[132:135], v[124:127], v[16:31]
    ds_read_b128 v[108:111], v179 offset:38912
    ds_read_b128 v[116:119], v179 offset:39936
    v_mfma_f32_32x32x16_bf16 v[32:47], v[140:143], v[124:127], v[32:47]
    v_mfma_f32_32x32x16_bf16 v[48:63], v[124:127], v[148:151], v[48:63]
    v_mfma_f32_32x32x16_bf16 v[64:79], v[156:159], v[124:127], v[64:79]
    s_waitcnt lgkmcnt(0)
    s_barrier
    v_mfma_f32_32x32x16_bf16 v[16:31], v[88:91], v[80:83], v[16:31]
    ds_read_b128 v[120:123], v177 offset:49152
    ds_read_b128 v[128:131], v179 offset:49152
    v_mfma_f32_32x32x16_bf16 v[32:47], v[96:99], v[80:83], v[32:47]
    ds_read_b128 v[136:139], v179 offset:50176
    ds_read_b128 v[144:147], v179 offset:51200
    v_mfma_f32_32x32x16_bf16 v[48:63], v[80:83], v[104:107], v[48:63]
    ds_read_b128 v[152:155], v179 offset:52224
    ds_read_b128 v[124:127], v177 offset:50176
    v_mfma_f32_32x32x16_bf16 v[64:79], v[112:115], v[80:83], v[64:79]
    ds_read_b128 v[132:135], v179 offset:53248
    ds_read_b128 v[140:143], v179 offset:54272
    v_mfma_f32_32x32x16_bf16 v[16:31], v[92:95], v[84:87], v[16:31]
    ds_read_b128 v[148:151], v179 offset:55296
    ds_read_b128 v[156:159], v179 offset:56320
    v_mfma_f32_32x32x16_bf16 v[32:47], v[100:103], v[84:87], v[32:47]
    v_mfma_f32_32x32x16_bf16 v[48:63], v[84:87], v[108:111], v[48:63]
    v_mfma_f32_32x32x16_bf16 v[64:79], v[116:119], v[84:87], v[64:79]
    s_waitcnt lgkmcnt(0)
    s_barrier
    v_mfma_f32_32x32x16_bf16 v[16:31], v[128:131], v[120:123], v[16:31]
    ds_read_b128 v[80:83], v178 offset:0
    ds_read_b128 v[88:91], v180 offset:0
    v_mfma_f32_32x32x16_bf16 v[32:47], v[136:139], v[120:123], v[32:47]
    ds_read_b128 v[96:99], v180 offset:1024
    ds_read_b128 v[104:107], v180 offset:2048
    v_mfma_f32_32x32x16_bf16 v[48:63], v[120:123], v[144:147], v[48:63]
    ds_read_b128 v[112:115], v180 offset:3072
    ds_read_b128 v[84:87], v178 offset:1024
    v_mfma_f32_32x32x16_bf16 v[64:79], v[152:155], v[120:123], v[64:79]
    ds_read_b128 v[92:95], v180 offset:4096
    ds_read_b128 v[100:103], v180 offset:5120
    v_mfma_f32_32x32x16_bf16 v[16:31], v[132:135], v[124:127], v[16:31]
    ds_read_b128 v[108:111], v180 offset:6144
    ds_read_b128 v[116:119], v180 offset:7168
    v_mfma_f32_32x32x16_bf16 v[32:47], v[140:143], v[124:127], v[32:47]
    ds_read_b64 v[192:193], v7
    ds_read_b64 v[184:185], v14 offset:0
    v_mfma_f32_32x32x16_bf16 v[48:63], v[124:127], v[148:151], v[48:63]
    ds_read_b64 v[186:187], v14 offset:512
    ds_read_b64 v[188:189], v14 offset:1024
    v_mfma_f32_32x32x16_bf16 v[64:79], v[156:159], v[124:127], v[64:79]
    ds_read_b64 v[190:191], v14 offset:1536
    s_waitcnt lgkmcnt(0)
    s_barrier
    v_mfma_f32_32x32x8bf16_1k v[16:31], v[184:185], v[192:193], v[16:31]
    ds_read_b128 v[120:123], v178 offset:16384
    ds_read_b128 v[128:131], v180 offset:16384
    v_mfma_f32_32x32x8bf16_1k v[32:47], v[186:187], v[192:193], v[32:47]
    ds_read_b128 v[136:139], v180 offset:17408
    ds_read_b128 v[144:147], v180 offset:18432
    v_mfma_f32_32x32x8bf16_1k v[48:63], v[192:193], v[188:189], v[48:63]
    ds_read_b128 v[152:155], v180 offset:19456
    ds_read_b128 v[124:127], v178 offset:17408
    v_mfma_f32_32x32x8bf16_1k v[64:79], v[190:191], v[192:193], v[64:79]
    ds_read_b128 v[132:135], v180 offset:20480
    ds_read_b128 v[140:143], v180 offset:21504
    v_mfma_f32_32x32x16_bf16 v[16:31], v[88:91], v[80:83], v[16:31]
    ds_read_b128 v[148:151], v180 offset:22528
    ds_read_b128 v[156:159], v180 offset:23552
    v_mfma_f32_32x32x16_bf16 v[32:47], v[96:99], v[80:83], v[32:47]
    v_mfma_f32_32x32x16_bf16 v[48:63], v[80:83], v[104:107], v[48:63]
    v_mfma_f32_32x32x16_bf16 v[64:79], v[112:115], v[80:83], v[64:79]
    v_mfma_f32_32x32x16_bf16 v[16:31], v[92:95], v[84:87], v[16:31]
    v_mfma_f32_32x32x16_bf16 v[32:47], v[100:103], v[84:87], v[32:47]
    v_mfma_f32_32x32x16_bf16 v[48:63], v[84:87], v[108:111], v[48:63]
    v_mfma_f32_32x32x16_bf16 v[64:79], v[116:119], v[84:87], v[64:79]
    s_waitcnt lgkmcnt(0)
    s_barrier
    v_mfma_f32_32x32x16_bf16 v[16:31], v[128:131], v[120:123], v[16:31]
    ds_read_b128 v[80:83], v178 offset:32768
    ds_read_b128 v[88:91], v180 offset:32768
    v_mfma_f32_32x32x16_bf16 v[32:47], v[136:139], v[120:123], v[32:47]
    ds_read_b128 v[96:99], v180 offset:33792
    ds_read_b128 v[104:107], v180 offset:34816
    v_mfma_f32_32x32x16_bf16 v[48:63], v[120:123], v[144:147], v[48:63]
    ds_read_b128 v[112:115], v180 offset:35840
    ds_read_b128 v[84:87], v178 offset:33792
    v_mfma_f32_32x32x16_bf16 v[64:79], v[152:155], v[120:123], v[64:79]
    ds_read_b128 v[92:95], v180 offset:36864
    ds_read_b128 v[100:103], v180 offset:37888
    v_mfma_f32_32x32x16_bf16 v[16:31], v[132:135], v[124:127], v[16:31]
    ds_read_b128 v[108:111], v180 offset:38912
    ds_read_b128 v[116:119], v180 offset:39936
    v_mfma_f32_32x32x16_bf16 v[32:47], v[140:143], v[124:127], v[32:47]
    ds_read_b64 v[194:195], v7 offset:1024
    v_mfma_f32_32x32x16_bf16 v[48:63], v[124:127], v[148:151], v[48:63]
    v_mfma_f32_32x32x16_bf16 v[64:79], v[156:159], v[124:127], v[64:79]
    s_waitcnt lgkmcnt(0)
    s_barrier
    v_mfma_f32_32x32x16_bf16 v[16:31], v[88:91], v[80:83], v[16:31]
    ds_read_b128 v[120:123], v178 offset:49152
    ds_read_b128 v[128:131], v180 offset:49152
    v_mfma_f32_32x32x16_bf16 v[32:47], v[96:99], v[80:83], v[32:47]
    ds_read_b128 v[136:139], v180 offset:50176
    ds_read_b128 v[144:147], v180 offset:51200
    v_mfma_f32_32x32x16_bf16 v[48:63], v[80:83], v[104:107], v[48:63]
    ds_read_b128 v[152:155], v180 offset:52224
    ds_read_b128 v[124:127], v178 offset:50176
    v_mfma_f32_32x32x16_bf16 v[64:79], v[112:115], v[80:83], v[64:79]
    ds_read_b128 v[132:135], v180 offset:53248
    ds_read_b128 v[140:143], v180 offset:54272
    v_mfma_f32_32x32x16_bf16 v[16:31], v[92:95], v[84:87], v[16:31]
    ds_read_b128 v[148:151], v180 offset:55296
    ds_read_b128 v[156:159], v180 offset:56320
    v_mfma_f32_32x32x16_bf16 v[32:47], v[100:103], v[84:87], v[32:47]
    ds_read_b128 v[160:163], v8 offset:0
    ds_read_b128 v[164:167], v8 offset:32
    v_mfma_f32_32x32x16_bf16 v[48:63], v[84:87], v[108:111], v[48:63]
    ds_read_b128 v[168:171], v8 offset:64
    ds_read_b128 v[172:175], v8 offset:96
    v_mfma_f32_32x32x16_bf16 v[64:79], v[116:119], v[84:87], v[64:79]
    s_waitcnt lgkmcnt(0)
    s_barrier
    v_mfma_f32_32x32x16_bf16 v[16:31], v[128:131], v[120:123], v[16:31]
    ds_read_b128 v[80:83], v177 offset:0
    ds_read_b128 v[88:91], v179 offset:0
    v_mfma_f32_32x32x16_bf16 v[32:47], v[136:139], v[120:123], v[32:47]
    ds_read_b128 v[96:99], v179 offset:1024
    ds_read_b128 v[104:107], v179 offset:2048
    v_mfma_f32_32x32x16_bf16 v[48:63], v[120:123], v[144:147], v[48:63]
    ds_read_b128 v[112:115], v179 offset:3072
    ds_read_b128 v[84:87], v177 offset:1024
    v_mfma_f32_32x32x16_bf16 v[64:79], v[152:155], v[120:123], v[64:79]
    ds_read_b128 v[92:95], v179 offset:4096
    ds_read_b128 v[100:103], v179 offset:5120
    v_mfma_f32_32x32x16_bf16 v[16:31], v[132:135], v[124:127], v[16:31]
    ds_read_b128 v[108:111], v179 offset:6144
    ds_read_b128 v[116:119], v179 offset:7168
    v_mfma_f32_32x32x16_bf16 v[32:47], v[140:143], v[124:127], v[32:47]
    v_mul_f32 v196, 0x3eae1a93, v194
    v_mul_f32 v197, 0x3eae1a93, v195
    v_mfma_f32_32x32x16_bf16 v[48:63], v[124:127], v[148:151], v[48:63]
    v_mfma_f32_32x32x16_bf16 v[64:79], v[156:159], v[124:127], v[64:79]
    s_waitcnt lgkmcnt(0)
    s_barrier
    v_mfma_f32_32x32x16_bf16 v[16:31], v[88:91], v[80:83], v[16:31]
    ds_read_b128 v[120:123], v177 offset:16384
    ds_read_b128 v[128:131], v179 offset:16384
    v_mfma_f32_32x32x16_bf16 v[32:47], v[96:99], v[80:83], v[32:47]
    ds_read_b128 v[136:139], v179 offset:17408
    ds_read_b128 v[144:147], v179 offset:18432
    v_mfma_f32_32x32x16_bf16 v[48:63], v[80:83], v[104:107], v[48:63]
    ds_read_b128 v[152:155], v179 offset:19456
    ds_read_b128 v[124:127], v177 offset:17408
    v_mfma_f32_32x32x16_bf16 v[64:79], v[112:115], v[80:83], v[64:79]
    ds_read_b128 v[132:135], v179 offset:20480
    ds_read_b128 v[140:143], v179 offset:21504
    v_mfma_f32_32x32x16_bf16 v[16:31], v[92:95], v[84:87], v[16:31]
    ds_read_b128 v[148:151], v179 offset:22528
    ds_read_b128 v[156:159], v179 offset:23552
    v_mfma_f32_32x32x16_bf16 v[32:47], v[100:103], v[84:87], v[32:47]
    v_mfma_f32_32x32x16_bf16 v[48:63], v[84:87], v[108:111], v[48:63]
    v_mfma_f32_32x32x16_bf16 v[64:79], v[116:119], v[84:87], v[64:79]
    s_waitcnt lgkmcnt(0)
    v_mfma_f32_32x32x16_bf16 v[16:31], v[128:131], v[120:123], v[16:31]
    v_mfma_f32_32x32x16_bf16 v[32:47], v[136:139], v[120:123], v[32:47]
    v_mfma_f32_32x32x16_bf16 v[16:31], v[132:135], v[124:127], v[16:31]
    v_mfma_f32_32x32x16_bf16 v[48:63], v[120:123], v[144:147], v[48:63]
    v_mfma_f32_32x32x16_bf16 v[32:47], v[140:143], v[124:127], v[32:47]
    v_mfma_f32_32x32x16_bf16 v[64:79], v[152:155], v[120:123], v[64:79]
    v_mfma_f32_32x32x16_bf16 v[48:63], v[124:127], v[148:151], v[48:63]
    v_mfma_f32_32x32x16_bf16 v[64:79], v[156:159], v[124:127], v[64:79]
    s_nop 6
    v_pk_mul_f32 v[16:17], v[16:17], v[196:197]
    v_pk_mul_f32 v[18:19], v[18:19], v[196:197]
    v_pk_mul_f32 v[20:21], v[20:21], v[196:197]
    v_pk_mul_f32 v[22:23], v[22:23], v[196:197]
    v_cvt_pk_bf16_f32 v80, v16, v17
    v_cvt_pk_bf16_f32 v81, v18, v19
    v_cvt_pk_bf16_f32 v82, v20, v21
    v_cvt_pk_bf16_f32 v83, v22, v23
    buffer_store_dwordx4 v[80:83], v204, s[16:19], s44 offen offset:0 sc1
    v_pk_mul_f32 v[24:25], v[24:25], v[196:197]
    v_pk_mul_f32 v[26:27], v[26:27], v[196:197]
    v_pk_mul_f32 v[28:29], v[28:29], v[196:197]
    v_pk_mul_f32 v[30:31], v[30:31], v[196:197]
    v_cvt_pk_bf16_f32 v84, v24, v25
    v_cvt_pk_bf16_f32 v85, v26, v27
    v_cvt_pk_bf16_f32 v86, v28, v29
    v_cvt_pk_bf16_f32 v87, v30, v31
    buffer_store_dwordx4 v[84:87], v204, s[16:19], s44 offen offset:512 sc1
    v_pk_mul_f32 v[32:33], v[32:33], v[194:195]
    v_pk_mul_f32 v[34:35], v[34:35], v[194:195]
    v_pk_mul_f32 v[36:37], v[36:37], v[194:195]
    v_pk_mul_f32 v[38:39], v[38:39], v[194:195]
    v_cvt_pk_bf16_f32 v88, v32, v33
    v_cvt_pk_bf16_f32 v89, v34, v35
    v_cvt_pk_bf16_f32 v90, v36, v37
    v_cvt_pk_bf16_f32 v91, v38, v39
    buffer_store_dwordx4 v[88:91], v206, s[16:19], s46 offen offset:0 sc1
    v_pk_mul_f32 v[40:41], v[40:41], v[194:195]
    v_pk_mul_f32 v[42:43], v[42:43], v[194:195]
    v_pk_mul_f32 v[44:45], v[44:45], v[194:195]
    v_pk_mul_f32 v[46:47], v[46:47], v[194:195]
    v_cvt_pk_bf16_f32 v92, v40, v41
    v_cvt_pk_bf16_f32 v93, v42, v43
    v_cvt_pk_bf16_f32 v94, v44, v45
    v_cvt_pk_bf16_f32 v95, v46, v47
    buffer_store_dwordx4 v[92:95], v206, s[16:19], s46 offen offset:512 sc1
    v_pk_mul_f32 v[68:69], v[68:69], v[194:195]
    v_pk_mul_f32 v[64:65], v[64:65], v[196:197]
    v_pk_mul_f32 v[66:67], v[66:67], v[194:195]
    v_cvt_pk_bf16_f32 v106, v68, v69
    v_cvt_pk_bf16_f32 v104, v64, v65
    v_cvt_pk_bf16_f32 v105, v66, v67
    ds_write_b16 v209, v106
    ds_write_b16_d16_hi v209, v106 offset:16
    ds_read_b128 v[120:123], v198
    v_pk_mul_f32 v[48:49], v[48:49], v[160:161]
    v_pk_mul_f32 v[50:51], v[50:51], v[162:163]
    v_pk_mul_f32 v[52:53], v[52:53], v[164:165]
    v_pk_mul_f32 v[54:55], v[54:55], v[166:167]
    v_cvt_pk_bf16_f32 v96, v48, v49
    v_cvt_pk_bf16_f32 v97, v50, v51
    v_cvt_pk_bf16_f32 v98, v52, v53
    v_cvt_pk_bf16_f32 v99, v54, v55
    buffer_store_dwordx4 v[96:99], v208, s[16:19], s46 offen offset:1152 sc1
    v_pk_mul_f32 v[56:57], v[56:57], v[168:169]
    v_pk_mul_f32 v[58:59], v[58:59], v[170:171]
    v_pk_mul_f32 v[60:61], v[60:61], v[172:173]
    v_pk_mul_f32 v[62:63], v[62:63], v[174:175]
    v_cvt_pk_bf16_f32 v100, v56, v57
    v_cvt_pk_bf16_f32 v101, v58, v59
    v_cvt_pk_bf16_f32 v102, v60, v61
    v_cvt_pk_bf16_f32 v103, v62, v63
    buffer_store_dwordx4 v[100:103], v208, s[16:19], s46 offen offset:1792 sc1
    buffer_store_dword v104, v205, s[16:19], s44 offen offset:1024
    buffer_store_dword v105, v207, s[16:19], s46 offen offset:1024
    s_waitcnt lgkmcnt(0)
    buffer_store_dwordx4 v[120:123], v199, s[16:19], s46 offen offset:1408 sc1
    s_branch L_L_qkvB_join1
L_L_qkvB_loader:
    s_and_b32 s36, s35, 1
    s_cmp_ge_u32 s35, 2
    s_cbranch_scc1 L_L_qkvB_helper
    s_lshl_b32 s52, s36, 12
    s_mul_i32 s53, s30, 147456
    s_add_u32 s53, s53, s52
    s_add_u32 s51, s52, 8192
    s_lshl_b32 s50, s31, 1
    s_add_u32 s50, s50, s36
    s_mul_i32 s50, s50, 73728
    s_add_u32 s55, s50, 36864
    v_cmp_gt_u32 vcc, 16, v5
    v_mov_b32 v7, 0x40000000
    s_nop 0
    v_cndmask_b32 v20, v7, v176, vcc
    s_waitcnt lgkmcnt(0)
    s_add_u32 s8, s4, s58
    s_addc_u32 s9, s5, 0
    s_mov_b32 s10, 2359296
    s_mov_b32 s11, 0x00020000
    s_add_u32 s12, s4, 0x2240000
    s_addc_u32 s13, s5, 0
    s_mov_b32 s14, 0x240000
    s_mov_b32 s15, 0x00020000
    s_add_u32 m0, s52, 0
    s_nop 0
    buffer_load_dwordx4 v176, s[8:11], s50 offen lds
    buffer_load_dwordx4 v176, s[8:11], s50 offen offset:1024 lds
    s_add_u32 m0, s52, 2048
    s_add_u32 s50, s50, 2048
    buffer_load_dwordx4 v176, s[8:11], s55 offen lds
    buffer_load_dwordx4 v176, s[8:11], s55 offen offset:1024 lds
    s_add_u32 s55, s55, 2048
    s_add_u32 m0, s51, 0
    s_nop 0
    buffer_load_dwordx4 v176, s[12:15], s53 offen offset:0 lds
    buffer_load_dwordx4 v176, s[12:15], s53 offen offset:1024 lds
    buffer_load_dwordx4 v176, s[12:15], s53 offen offset:2048 lds
    buffer_load_dwordx4 v20, s[12:15], s53 offen offset:3072 lds
    s_add_u32 s53, s53, 8192
    s_add_u32 m0, s52, 16384
    s_nop 0
    buffer_load_dwordx4 v176, s[8:11], s50 offen lds
    buffer_load_dwordx4 v176, s[8:11], s50 offen offset:1024 lds
    s_add_u32 m0, s52, 18432
    s_add_u32 s50, s50, 2048
    buffer_load_dwordx4 v176, s[8:11], s55 offen lds
    buffer_load_dwordx4 v176, s[8:11], s55 offen offset:1024 lds
    s_add_u32 s55, s55, 2048
    s_add_u32 m0, s51, 16384
    s_nop 0
    buffer_load_dwordx4 v176, s[12:15], s53 offen offset:0 lds
    buffer_load_dwordx4 v176, s[12:15], s53 offen offset:1024 lds
    buffer_load_dwordx4 v176, s[12:15], s53 offen offset:2048 lds
    buffer_load_dwordx4 v20, s[12:15], s53 offen offset:3072 lds
    s_add_u32 s53, s53, 8192
    s_add_u32 m0, s52, 32768
    s_nop 0
    buffer_load_dwordx4 v176, s[8:11], s50 offen lds
    buffer_load_dwordx4 v176, s[8:11], s50 offen offset:1024 lds
    s_add_u32 m0, s52, 34816
    s_add_u32 s50, s50, 2048
    buffer_load_dwordx4 v176, s[8:11], s55 offen lds
    buffer_load_dwordx4 v176, s[8:11], s55 offen offset:1024 lds
    s_add_u32 s55, s55, 2048
    s_add_u32 m0, s51, 32768
    s_nop 0
    buffer_load_dwordx4 v176, s[12:15], s53 offen offset:0 lds
    buffer_load_dwordx4 v176, s[12:15], s53 offen offset:1024 lds
    buffer_load_dwordx4 v176, s[12:15], s53 offen offset:2048 lds
    buffer_load_dwordx4 v20, s[12:15], s53 offen offset:3072 lds
    s_add_u32 s53, s53, 8192
    s_add_u32 m0, s52, 49152
    s_nop 0
    buffer_load_dwordx4 v176, s[8:11], s50 offen lds
    buffer_load_dwordx4 v176, s[8:11], s50 offen offset:1024 lds
    s_add_u32 m0, s52, 51200
    s_add_u32 s50, s50, 2048
    buffer_load_dwordx4 v176, s[8:11], s55 offen lds
    buffer_load_dwordx4 v176, s[8:11], s55 offen offset:1024 lds
    s_add_u32 s55, s55, 2048
    s_add_u32 m0, s51, 49152
    s_nop 0
    buffer_load_dwordx4 v176, s[12:15], s53 offen offset:0 lds
    buffer_load_dwordx4 v176, s[12:15], s53 offen offset:1024 lds
    buffer_load_dwordx4 v176, s[12:15], s53 offen offset:2048 lds
    buffer_load_dwordx4 v20, s[12:15], s53 offen offset:3072 lds
    s_add_u32 s53, s53, 8192
    s_waitcnt vmcnt(16)
    s_barrier
    s_add_u32 m0, s52, 65536
    s_nop 0
    buffer_load_dwordx4 v176, s[8:11], s50 offen lds
    buffer_load_dwordx4 v176, s[8:11], s50 offen offset:1024 lds
    s_add_u32 m0, s52, 67584
    s_add_u32 s50, s50, 2048
    buffer_load_dwordx4 v176, s[8:11], s55 offen lds
    buffer_load_dwordx4 v176, s[8:11], s55 offen offset:1024 lds
    s_add_u32 s55, s55, 2048
    s_add_u32 m0, s51, 65536
    s_nop 0
    buffer_load_dwordx4 v176, s[12:15], s53 offen offset:0 lds
    buffer_load_dwordx4 v176, s[12:15], s53 offen offset:1024 lds
    buffer_load_dwordx4 v176, s[12:15], s53 offen offset:2048 lds
    buffer_load_dwordx4 v20, s[12:15], s53 offen offset:3072 lds
    s_add_u32 s53, s53, 8192
    s_waitcnt vmcnt(16)
    s_barrier
    s_add_u32 m0, s52, 81920
    s_nop 0
    buffer_load_dwordx4 v176, s[8:11], s50 offen lds
    buffer_load_dwordx4 v176, s[8:11], s50 offen offset:1024 lds
    s_add_u32 m0, s52, 83968
    s_add_u32 s50, s50, 2048
    buffer_load_dwordx4 v176, s[8:11], s55 offen lds
    buffer_load_dwordx4 v176, s[8:11], s55 offen offset:1024 lds
    s_add_u32 s55, s55, 2048
    s_add_u32 m0, s51, 81920
    s_nop 0
    buffer_load_dwordx4 v176, s[12:15], s53 offen offset:0 lds
    buffer_load_dwordx4 v176, s[12:15], s53 offen offset:1024 lds
    buffer_load_dwordx4 v176, s[12:15], s53 offen offset:2048 lds
    buffer_load_dwordx4 v20, s[12:15], s53 offen offset:3072 lds
    s_add_u32 s53, s53, 8192
    s_waitcnt vmcnt(16)
    s_barrier
    s_add_u32 m0, s52, 98304
    s_nop 0
    buffer_load_dwordx4 v176, s[8:11], s50 offen lds
    buffer_load_dwordx4 v176, s[8:11], s50 offen offset:1024 lds
    s_add_u32 m0, s52, 100352
    s_add_u32 s50, s50, 2048
    buffer_load_dwordx4 v176, s[8:11], s55 offen lds
    buffer_load_dwordx4 v176, s[8:11], s55 offen offset:1024 lds
    s_add_u32 s55, s55, 2048
    s_add_u32 m0, s51, 98304
    s_nop 0
    buffer_load_dwordx4 v176, s[12:15], s53 offen offset:0 lds
    buffer_load_dwordx4 v176, s[12:15], s53 offen offset:1024 lds
    buffer_load_dwordx4 v176, s[12:15], s53 offen offset:2048 lds
    buffer_load_dwordx4 v20, s[12:15], s53 offen offset:3072 lds
    s_add_u32 s53, s53, 8192
    s_waitcnt vmcnt(16)
    s_barrier
    s_add_u32 m0, s52, 114688
    s_nop 0
    buffer_load_dwordx4 v176, s[8:11], s50 offen lds
    buffer_load_dwordx4 v176, s[8:11], s50 offen offset:1024 lds
    s_add_u32 m0, s52, 116736
    s_add_u32 s50, s50, 2048
    buffer_load_dwordx4 v176, s[8:11], s55 offen lds
    buffer_load_dwordx4 v176, s[8:11], s55 offen offset:1024 lds
    s_add_u32 s55, s55, 2048
    s_add_u32 m0, s51, 114688
    s_nop 0
    buffer_load_dwordx4 v176, s[12:15], s53 offen offset:0 lds
    buffer_load_dwordx4 v176, s[12:15], s53 offen offset:1024 lds
    buffer_load_dwordx4 v176, s[12:15], s53 offen offset:2048 lds
    buffer_load_dwordx4 v20, s[12:15], s53 offen offset:3072 lds
    s_add_u32 s53, s53, 8192
    s_waitcnt vmcnt(16)
    s_barrier
    s_add_u32 m0, s52, 0
    s_nop 0
    buffer_load_dwordx4 v176, s[8:11], s50 offen lds
    buffer_load_dwordx4 v176, s[8:11], s50 offen offset:1024 lds
    s_add_u32 m0, s52, 2048
    s_add_u32 s50, s50, 2048
    buffer_load_dwordx4 v176, s[8:11], s55 offen lds
    buffer_load_dwordx4 v176, s[8:11], s55 offen offset:1024 lds
    s_add_u32 s55, s55, 2048
    s_add_u32 m0, s51, 0
    s_nop 0
    buffer_load_dwordx4 v176, s[12:15], s53 offen offset:0 lds
    buffer_load_dwordx4 v176, s[12:15], s53 offen offset:1024 lds
    buffer_load_dwordx4 v176, s[12:15], s53 offen offset:2048 lds
    buffer_load_dwordx4 v20, s[12:15], s53 offen offset:3072 lds
    s_add_u32 s53, s53, 8192
    s_waitcnt vmcnt(16)
    s_barrier
    s_add_u32 m0, s52, 16384
    s_nop 0
    buffer_load_dwordx4 v176, s[8:11], s50 offen lds
    buffer_load_dwordx4 v176, s[8:11], s50 offen offset:1024 lds
    s_add_u32 m0, s52, 18432
    s_add_u32 s50, s50, 2048
    buffer_load_dwordx4 v176, s[8:11], s55 offen lds
    buffer_load_dwordx4 v176, s[8:11], s55 offen offset:1024 lds
    s_add_u32 s55, s55, 2048
    s_add_u32 m0, s51, 16384
    s_nop 0
    buffer_load_dwordx4 v176, s[12:15], s53 offen offset:0 lds
    buffer_load_dwordx4 v176, s[12:15], s53 offen offset:1024 lds
    buffer_load_dwordx4 v176, s[12:15], s53 offen offset:2048 lds
    buffer_load_dwordx4 v20, s[12:15], s53 offen offset:3072 lds
    s_add_u32 s53, s53, 8192
    s_waitcnt vmcnt(16)
    s_barrier
    s_add_u32 m0, s52, 32768
    s_nop 0
    buffer_load_dwordx4 v176, s[8:11], s50 offen lds
    buffer_load_dwordx4 v176, s[8:11], s50 offen offset:1024 lds
    s_add_u32 m0, s52, 34816
    s_add_u32 s50, s50, 2048
    buffer_load_dwordx4 v176, s[8:11], s55 offen lds
    buffer_load_dwordx4 v176, s[8:11], s55 offen offset:1024 lds
    s_add_u32 s55, s55, 2048
    s_add_u32 m0, s51, 32768
    s_nop 0
    buffer_load_dwordx4 v176, s[12:15], s53 offen offset:0 lds
    buffer_load_dwordx4 v176, s[12:15], s53 offen offset:1024 lds
    buffer_load_dwordx4 v176, s[12:15], s53 offen offset:2048 lds
    buffer_load_dwordx4 v20, s[12:15], s53 offen offset:3072 lds
    s_add_u32 s53, s53, 8192
    s_waitcnt vmcnt(16)
    s_barrier
    s_add_u32 m0, s52, 49152
    s_nop 0
    buffer_load_dwordx4 v176, s[8:11], s50 offen lds
    buffer_load_dwordx4 v176, s[8:11], s50 offen offset:1024 lds
    s_add_u32 m0, s52, 51200
    s_add_u32 s50, s50, 2048
    buffer_load_dwordx4 v176, s[8:11], s55 offen lds
    buffer_load_dwordx4 v176, s[8:11], s55 offen offset:1024 lds
    s_add_u32 s55, s55, 2048
    s_add_u32 m0, s51, 49152
    s_nop 0
    buffer_load_dwordx4 v176, s[12:15], s53 offen offset:0 lds
    buffer_load_dwordx4 v176, s[12:15], s53 offen offset:1024 lds
    buffer_load_dwordx4 v176, s[12:15], s53 offen offset:2048 lds
    buffer_load_dwordx4 v20, s[12:15], s53 offen offset:3072 lds
    s_add_u32 s53, s53, 8192
    s_waitcnt vmcnt(16)
    s_barrier
    s_add_u32 m0, s52, 65536
    s_nop 0
    buffer_load_dwordx4 v176, s[8:11], s50 offen lds
    buffer_load_dwordx4 v176, s[8:11], s50 offen offset:1024 lds
    s_add_u32 m0, s52, 67584
    s_add_u32 s50, s50, 2048
    buffer_load_dwordx4 v176, s[8:11], s55 offen lds
    buffer_load_dwordx4 v176, s[8:11], s55 offen offset:1024 lds
    s_add_u32 s55, s55, 2048
    s_add_u32 m0, s51, 65536
    s_nop 0
    buffer_load_dwordx4 v176, s[12:15], s53 offen offset:0 lds
    buffer_load_dwordx4 v176, s[12:15], s53 offen offset:1024 lds
    buffer_load_dwordx4 v176, s[12:15], s53 offen offset:2048 lds
    buffer_load_dwordx4 v20, s[12:15], s53 offen offset:3072 lds
    s_add_u32 s53, s53, 8192
    s_waitcnt vmcnt(16)
    s_barrier
    s_add_u32 m0, s52, 81920
    s_nop 0
    buffer_load_dwordx4 v176, s[8:11], s50 offen lds
    buffer_load_dwordx4 v176, s[8:11], s50 offen offset:1024 lds
    s_add_u32 m0, s52, 83968
    s_add_u32 s50, s50, 2048
    buffer_load_dwordx4 v176, s[8:11], s55 offen lds
    buffer_load_dwordx4 v176, s[8:11], s55 offen offset:1024 lds
    s_add_u32 s55, s55, 2048
    s_add_u32 m0, s51, 81920
    s_nop 0
    buffer_load_dwordx4 v176, s[12:15], s53 offen offset:0 lds
    buffer_load_dwordx4 v176, s[12:15], s53 offen offset:1024 lds
    buffer_load_dwordx4 v176, s[12:15], s53 offen offset:2048 lds
    buffer_load_dwordx4 v20, s[12:15], s53 offen offset:3072 lds
    s_add_u32 s53, s53, 8192
    s_waitcnt vmcnt(16)
    s_barrier
    s_add_u32 m0, s52, 98304
    s_nop 0
    buffer_load_dwordx4 v176, s[8:11], s50 offen lds
    buffer_load_dwordx4 v176, s[8:11], s50 offen offset:1024 lds
    s_add_u32 m0, s52, 100352
    s_add_u32 s50, s50, 2048
    buffer_load_dwordx4 v176, s[8:11], s55 offen lds
    buffer_load_dwordx4 v176, s[8:11], s55 offen offset:1024 lds
    s_add_u32 s55, s55, 2048
    s_add_u32 m0, s51, 98304
    s_nop 0
    buffer_load_dwordx4 v176, s[12:15], s53 offen offset:0 lds
    buffer_load_dwordx4 v176, s[12:15], s53 offen offset:1024 lds
    buffer_load_dwordx4 v176, s[12:15], s53 offen offset:2048 lds
    buffer_load_dwordx4 v20, s[12:15], s53 offen offset:3072 lds
    s_add_u32 s53, s53, 8192
    s_waitcnt vmcnt(16)
    s_barrier
    s_add_u32 m0, s52, 114688
    s_nop 0
    buffer_load_dwordx4 v176, s[8:11], s50 offen lds
    buffer_load_dwordx4 v176, s[8:11], s50 offen offset:1024 lds
    s_add_u32 m0, s52, 116736
    s_add_u32 s50, s50, 2048
    buffer_load_dwordx4 v176, s[8:11], s55 offen lds
    buffer_load_dwordx4 v176, s[8:11], s55 offen offset:1024 lds
    s_add_u32 s55, s55, 2048
    s_add_u32 m0, s51, 114688
    s_nop 0
    buffer_load_dwordx4 v176, s[12:15], s53 offen offset:0 lds
    buffer_load_dwordx4 v176, s[12:15], s53 offen offset:1024 lds
    buffer_load_dwordx4 v176, s[12:15], s53 offen offset:2048 lds
    buffer_load_dwordx4 v20, s[12:15], s53 offen offset:3072 lds
    s_add_u32 s53, s53, 8192
    s_waitcnt vmcnt(16)
    s_barrier
    s_add_u32 m0, s52, 0
    s_nop 0
    buffer_load_dwordx4 v176, s[8:11], s50 offen lds
    buffer_load_dwordx4 v176, s[8:11], s50 offen offset:1024 lds
    s_add_u32 m0, s52, 2048
    s_add_u32 s50, s50, 2048
    buffer_load_dwordx4 v176, s[8:11], s55 offen lds
    buffer_load_dwordx4 v176, s[8:11], s55 offen offset:1024 lds
    s_add_u32 s55, s55, 2048
    s_add_u32 m0, s51, 0
    s_nop 0
    buffer_load_dwordx4 v176, s[12:15], s53 offen offset:0 lds
    buffer_load_dwordx4 v176, s[12:15], s53 offen offset:1024 lds
    buffer_load_dwordx4 v176, s[12:15], s53 offen offset:2048 lds
    buffer_load_dwordx4 v20, s[12:15], s53 offen offset:3072 lds
    s_add_u32 s53, s53, 8192
    s_waitcnt vmcnt(16)
    s_barrier
    s_add_u32 m0, s52, 16384
    s_nop 0
    buffer_load_dwordx4 v176, s[8:11], s50 offen lds
    buffer_load_dwordx4 v176, s[8:11], s50 offen offset:1024 lds
    s_add_u32 m0, s52, 18432
    s_add_u32 s50, s50, 2048
    buffer_load_dwordx4 v176, s[8:11], s55 offen lds
    buffer_load_dwordx4 v176, s[8:11], s55 offen offset:1024 lds
    s_add_u32 s55, s55, 2048
    s_add_u32 m0, s51, 16384
    s_nop 0
    buffer_load_dwordx4 v176, s[12:15], s53 offen offset:0 lds
    buffer_load_dwordx4 v176, s[12:15], s53 offen offset:1024 lds
    buffer_load_dwordx4 v176, s[12:15], s53 offen offset:2048 lds
    buffer_load_dwordx4 v20, s[12:15], s53 offen offset:3072 lds
    s_add_u32 s53, s53, 8192
    s_waitcnt vmcnt(16)
    s_barrier
    s_waitcnt vmcnt(8)
    s_barrier
    s_waitcnt vmcnt(0)
    s_barrier
    s_endpgm
L_L_qkvB_helper:
    s_lshl_b32 s34, s31, 14
    s_add_u32 s57, s34, s57
    s_lshl_b32 s34, s36, 13
    s_add_u32 s57, s34, s57
    v_lshrrev_b32 v11, 3, v3
    v_and_b32 v12, 7, v3
    v_lshlrev_b32 v11, 10, v11
    v_lshl_add_u32 v11, v12, 4, v11
    s_lshl_b32 s54, s30, 9
    s_lshl_b32 s34, s36, 8
    s_add_u32 s54, s54, s34
    s_add_u32 s54, s54, 0x148c000
    v_lshlrev_b32 v7, 2, v5
    v_lshl_add_u32 v8, v6, 30, v7
    v_add_u32 v8, 16384, v8
    v_lshl_add_u32 v7, v6, 13, v7
    s_waitcnt lgkmcnt(0)
    s_mov_b32 s16, s4
    s_mov_b32 s17, s5
    s_mov_b32 s18, 0x8000000
    s_mov_b32 s19, 0x00020000
    buffer_load_dwordx4 v[128:131], v11, s[16:19], s57 offen offset:0
    buffer_load_dwordx4 v[132:135], v11, s[16:19], s57 offen offset:128
    buffer_load_dwordx4 v[136:139], v11, s[16:19], s57 offen offset:256
    buffer_load_dwordx4 v[140:143], v11, s[16:19], s57 offen offset:384
    buffer_load_dwordx4 v[144:147], v11, s[16:19], s57 offen offset:512
    buffer_load_dwordx4 v[148:151], v11, s[16:19], s57 offen offset:640
    buffer_load_dwordx4 v[152:155], v11, s[16:19], s57 offen offset:768
    buffer_load_dwordx4 v[156:159], v11, s[16:19], s57 offen offset:896
    buffer_load_dword v160, v7, s[16:19], s54 offen offset:0
    buffer_load_dword v164, v7, s[16:19], s54 offen offset:128
    s_add_u32 s54, s54, 16384
    buffer_load_dword v161, v7, s[16:19], s54 offen offset:0
    buffer_load_dword v165, v7, s[16:19], s54 offen offset:128
    s_add_u32 s54, s54, 16384
    buffer_load_dword v162, v7, s[16:19], s54 offen offset:0
    buffer_load_dword v166, v7, s[16:19], s54 offen offset:128
    s_add_u32 s54, s54, 16384
    s_barrier
    s_barrier
    s_waitcnt vmcnt(0)
    v_pk_add_f32 v[128:129], v[128:129], v[130:131]
    v_pk_add_f32 v[132:133], v[132:133], v[134:135]
    v_pk_add_f32 v[136:137], v[136:137], v[138:139]
    v_pk_add_f32 v[140:141], v[140:141], v[142:143]
    v_pk_add_f32 v[144:145], v[144:145], v[146:147]
    v_pk_add_f32 v[148:149], v[148:149], v[150:151]
    v_pk_add_f32 v[152:153], v[152:153], v[154:155]
    v_pk_add_f32 v[156:157], v[156:157], v[158:159]
    v_add_f32_dpp v130, v128, v128 quad_perm:[1,0,3,2] row_mask:0xf bank_mask:0xf
    v_add_f32_dpp v131, v129, v129 quad_perm:[1,0,3,2] row_mask:0xf bank_mask:0xf
    v_add_f32_dpp v134, v132, v132 quad_perm:[1,0,3,2] row_mask:0xf bank_mask:0xf
    v_add_f32_dpp v135, v133, v133 quad_perm:[1,0,3,2] row_mask:0xf bank_mask:0xf
    v_add_f32_dpp v138, v136, v136 quad_perm:[1,0,3,2] row_mask:0xf bank_mask:0xf
    s_barrier
    v_add_f32_dpp v139, v137, v137 quad_perm:[1,0,3,2] row_mask:0xf bank_mask:0xf
    v_add_f32_dpp v142, v140, v140 quad_perm:[1,0,3,2] row_mask:0xf bank_mask:0xf
    v_add_f32_dpp v143, v141, v141 quad_perm:[1,0,3,2] row_mask:0xf bank_mask:0xf
    v_add_f32_dpp v146, v144, v144 quad_perm:[1,0,3,2] row_mask:0xf bank_mask:0xf
    v_add_f32_dpp v147, v145, v145 quad_perm:[1,0,3,2] row_mask:0xf bank_mask:0xf
    v_add_f32_dpp v150, v148, v148 quad_perm:[1,0,3,2] row_mask:0xf bank_mask:0xf
    v_add_f32_dpp v151, v149, v149 quad_perm:[1,0,3,2] row_mask:0xf bank_mask:0xf
    v_add_f32_dpp v154, v152, v152 quad_perm:[1,0,3,2] row_mask:0xf bank_mask:0xf
    v_add_f32_dpp v155, v153, v153 quad_perm:[1,0,3,2] row_mask:0xf bank_mask:0xf
    v_add_f32_dpp v158, v156, v156 quad_perm:[1,0,3,2] row_mask:0xf bank_mask:0xf
    v_add_f32_dpp v159, v157, v157 quad_perm:[1,0,3,2] row_mask:0xf bank_mask:0xf
    v_add_f32_dpp v128, v130, v130 quad_perm:[2,3,0,1] row_mask:0xf bank_mask:0xf
    v_add_f32_dpp v129, v131, v131 quad_perm:[2,3,0,1] row_mask:0xf bank_mask:0xf
    v_add_f32_dpp v132, v134, v134 quad_perm:[2,3,0,1] row_mask:0xf bank_mask:0xf
    s_barrier
    v_add_f32_dpp v133, v135, v135 quad_perm:[2,3,0,1] row_mask:0xf bank_mask:0xf
    v_add_f32_dpp v136, v138, v138 quad_perm:[2,3,0,1] row_mask:0xf bank_mask:0xf
    v_add_f32_dpp v137, v139, v139 quad_perm:[2,3,0,1] row_mask:0xf bank_mask:0xf
    v_add_f32_dpp v140, v142, v142 quad_perm:[2,3,0,1] row_mask:0xf bank_mask:0xf
    v_add_f32_dpp v141, v143, v143 quad_perm:[2,3,0,1] row_mask:0xf bank_mask:0xf
    v_add_f32_dpp v144, v146, v146 quad_perm:[2,3,0,1] row_mask:0xf bank_mask:0xf
    v_add_f32_dpp v145, v147, v147 quad_perm:[2,3,0,1] row_mask:0xf bank_mask:0xf
    v_add_f32_dpp v148, v150, v150 quad_perm:[2,3,0,1] row_mask:0xf bank_mask:0xf
    v_add_f32_dpp v149, v151, v151 quad_perm:[2,3,0,1] row_mask:0xf bank_mask:0xf
    v_add_f32_dpp v152, v154, v154 quad_perm:[2,3,0,1] row_mask:0xf bank_mask:0xf
    v_add_f32_dpp v153, v155, v155 quad_perm:[2,3,0,1] row_mask:0xf bank_mask:0xf
    v_add_f32_dpp v156, v158, v158 quad_perm:[2,3,0,1] row_mask:0xf bank_mask:0xf
    v_add_f32_dpp v157, v159, v159 quad_perm:[2,3,0,1] row_mask:0xf bank_mask:0xf
    v_add_f32_dpp v130, v128, v128 row_half_mirror row_mask:0xf bank_mask:0xf
    s_barrier
    v_add_f32_dpp v131, v129, v129 row_half_mirror row_mask:0xf bank_mask:0xf
    v_add_f32_dpp v134, v132, v132 row_half_mirror row_mask:0xf bank_mask:0xf
    v_add_f32_dpp v135, v133, v133 row_half_mirror row_mask:0xf bank_mask:0xf
    v_add_f32_dpp v138, v136, v136 row_half_mirror row_mask:0xf bank_mask:0xf
    v_add_f32_dpp v139, v137, v137 row_half_mirror row_mask:0xf bank_mask:0xf
    v_add_f32_dpp v142, v140, v140 row_half_mirror row_mask:0xf bank_mask:0xf
    v_add_f32_dpp v143, v141, v141 row_half_mirror row_mask:0xf bank_mask:0xf
    v_add_f32_dpp v146, v144, v144 row_half_mirror row_mask:0xf bank_mask:0xf
    v_add_f32_dpp v147, v145, v145 row_half_mirror row_mask:0xf bank_mask:0xf
    v_add_f32_dpp v150, v148, v148 row_half_mirror row_mask:0xf bank_mask:0xf
    v_add_f32_dpp v151, v149, v149 row_half_mirror row_mask:0xf bank_mask:0xf
    v_add_f32_dpp v154, v152, v152 row_half_mirror row_mask:0xf bank_mask:0xf
    v_add_f32_dpp v155, v153, v153 row_half_mirror row_mask:0xf bank_mask:0xf
    v_add_f32_dpp v158, v156, v156 row_half_mirror row_mask:0xf bank_mask:0xf
    s_barrier
    v_add_f32_dpp v159, v157, v157 row_half_mirror row_mask:0xf bank_mask:0xf
    v_and_b32 v9, 7, v3
    v_cmp_eq_u32 vcc, 1, v9
    s_nop 1
    v_cndmask_b32 v130, v130, v134, vcc
    v_cndmask_b32 v131, v131, v135, vcc
    v_cmp_eq_u32 vcc, 2, v9
    s_nop 1
    v_cndmask_b32 v130, v130, v138, vcc
    v_cndmask_b32 v131, v131, v139, vcc
    v_cmp_eq_u32 vcc, 3, v9
    s_nop 1
    v_cndmask_b32 v130, v130, v142, vcc
    v_cndmask_b32 v131, v131, v143, vcc
    s_barrier
    v_cmp_eq_u32 vcc, 4, v9
    s_nop 1
    v_cndmask_b32 v130, v130, v146, vcc
    v_cndmask_b32 v131, v131, v147, vcc
    v_cmp_eq_u32 vcc, 5, v9
    s_nop 1
    v_cndmask_b32 v130, v130, v150, vcc
    v_cndmask_b32 v131, v131, v151, vcc
    v_cmp_eq_u32 vcc, 6, v9
    s_nop 1
    v_cndmask_b32 v130, v130, v154, vcc
    v_cndmask_b32 v131, v131, v155, vcc
    v_cmp_eq_u32 vcc, 7, v9
    s_nop 1
    v_cndmask_b32 v130, v130, v158, vcc
    v_cndmask_b32 v131, v131, v159, vcc
    s_barrier
    v_mul_f32 v128, 0xbae38e39, v130
    v_mul_f32 v129, 0x3ae38e39, v131
    v_fma_f32 v129, -v128, v128, v129
    v_cvt_pk_bf16_f32 v130, v128, v128
    v_max_f32 v129, 0, v129
    v_and_b32 v130, 0xffff0000, v130
    v_add_f32 v129, 0x3727c5ac, v129
    v_sub_f32 v130, v128, v130
    v_rsq_f32 v132, v129
    v_cvt_pk_bf16_f32 v130, v128, v130
    v_mov_b32 v133, v132
    v_mov_b32 v131, v130
    s_lshl_b32 s34, s36, 6
    v_add_u32 v10, s34, v3
    s_barrier
    v_lshlrev_b32 v11, 3, v10
    v_lshlrev_b32 v10, 2, v10
    v_add_u32 v11, 134144, v11
    v_add_u32 v10, 136192, v10
    ds_write_b64 v11, v[130:131]
    ds_write_b64 v11, v[132:133] offset:1024
    ds_write_b32 v10, v132
    s_lshl_b32 s34, s36, 10
    s_add_u32 s34, s34, 136704
    v_lshl_add_u32 v10, v3, 3, s34
    v_add_f32 v160, v160, v161
    v_add_f32 v160, v160, v162
    v_cvt_pk_bf16_f32 v162, v160, v160
    v_and_b32 v9, 0xffff0000, v162
    s_barrier
    v_sub_f32 v9, v160, v9
    v_cvt_pk_bf16_f32 v163, v9, v9
    ds_write_b64 v10, v[162:163] offset:0
    v_add_f32 v164, v164, v165
    v_add_f32 v164, v164, v166
    v_cvt_pk_bf16_f32 v166, v164, v164
    v_and_b32 v9, 0xffff0000, v166
    v_sub_f32 v9, v164, v9
    v_cvt_pk_bf16_f32 v167, v9, v9
    ds_write_b64 v10, v[166:167] offset:512
    s_waitcnt lgkmcnt(0)
    s_barrier
    s_barrier
    v_subrev_u32 v0, 128, v0
    s_getpc_b64 s[20:21]
L_L_qkvB_pc2:
    s_sub_u32 s20, s20, L_L_qkvB_pc2-L_text_start
    s_subb_u32 s21, s21, 0
    s_mov_b32 s22, L_text_end-L_text_start
    s_mov_b32 s23, 0x00020000
    s_cmp_lt_u32 s2, 16
    s_cselect_b32 s34, 0, 0x40000000
    v_lshl_add_u32 v23, v0, 7, s34
    v_add_u32 v0, 128, v0
    s_barrier
    s_barrier
    s_barrier
    s_barrier
    buffer_load_dword v26, v23, s[20:23], 0 offen
    v_add_u32 v23, 16384, v23
    buffer_load_dword v26, v23, s[20:23], 0 offen
    v_add_u32 v23, 16384, v23
    buffer_load_dword v26, v23, s[20:23], 0 offen
    v_add_u32 v23, 16384, v23
    buffer_load_dword v26, v23, s[20:23], 0 offen
    v_add_u32 v23, 16384, v23
    s_barrier
L_L_qkvB_join1:
    s_waitcnt vmcnt(0)
L_L_qkvB_end:
    s_endpgm
.globl out_a1_kernel
.p2align 8
.type out_a1_kernel,@function
out_a1_kernel:
    s_mov_b32 s60, 0x1d00000
    s_mov_b32 s61, 0x0
    s_mov_b32 s62, 0x1400000
    s_mov_b32 s63, 0x1540000
    s_mov_b32 s59, 0x1a00000
    s_branch L_outA
.globl out_a2_kernel
.p2align 8
.type out_a2_kernel,@function
out_a2_kernel:
    s_mov_b32 s60, 0x240000
    s_mov_b32 s61, 0x480000
    s_mov_b32 s62, 0x1413000
    s_mov_b32 s63, 0x15c0000
    s_mov_b32 s59, 0x1a00000
    s_branch L_outA
.p2align 8
L_outA:
    s_cmp_ge_u32 s2, 256
    s_cbranch_scc1 L_L_outA_end
    s_load_dwordx2 s[4:5], s[0:1], 64
    v_lshrrev_b32 v4, 6, v0
    s_and_b32 s28, s2, 7
    s_lshr_b32 s29, s2, 3
    v_readfirstlane_b32 s35, v4
    s_and_b32 s30, s29, 7
    s_lshr_b32 s31, s29, 3
    s_lshl_b32 s32, s28, 2
    s_add_u32 s31, s31, s32
    v_and_b32 v3, 63, v0
    v_lshlrev_b32 v15, 4, v3
    s_cmp_lt_u32 s35, 4
    s_cbranch_scc1 L_L_outA_loader
    s_cmp_ge_u32 s35, 8
    s_cbranch_scc1 L_L_outA_st1
    v_and_b32 v5, 15, v3
    v_lshrrev_b32 v6, 4, v3
    s_and_b32 s36, s35, 1
    s_bfe_u32 s37, s35, 0x10001
    s_lshl_b32 s38, s31, 1
    s_add_u32 s38, s38, s36
    s_mul_i32 s40, s38, 36864
    s_mul_i32 s41, s30, 4608
    s_add_u32 s40, s40, s41
    v_and_b32 v11, 1, v6
    v_lshrrev_b32 v7, 1, v6
    v_lshl_add_u32 v12, v11, 1, v7
    s_lshl_b32 s41, s37, 2
    v_add_u32 v12, s41, v12
    v_lshlrev_b32 v13, 9, v12
    v_lshl_add_u32 v13, v5, 4, v13
    v_add_u32 v110, s40, v13
    v_lshlrev_b32 v13, 4, v5
    v_lshl_add_u32 v13, v6, 3, v13
    v_add_u32 v13, s40, v13
    v_add_u32 v13, 4096, v13
    v_cmp_gt_u32 s[48:49], 2, v6
    v_mov_b32 v14, 0x40000000
    s_lshl_b32 s41, s38, 5
    v_cndmask_b32 v111, v14, v13, s[48:49]
    s_mov_b32 s43, 256
    s_lshl_b32 s39, s38, 12
    s_lshl_b32 s41, s30, 4
    s_add_u32 s39, s39, s41
    s_lshl_b32 s41, s37, 3
    s_add_u32 s39, s39, s41
    v_lshlrev_b32 v13, 7, v3
    v_cmp_gt_u32 vcc, 2, v6
    s_lshl_b32 s41, s37, 11
    v_add_u32 v108, s41, v15
    v_cndmask_b32 v115, v14, v13, vcc
    v_and_b32 v13, 7, v5
    v_lshlrev_b32 v13, 4, v13
    v_lshl_add_u32 v109, v6, 7, v13
    s_mul_i32 s41, s36, 36864
    s_add_u32 s41, s41, 82944
    v_mul_u32_u24 v8, 1152, v7
    v_lshl_add_u32 v8, v11, 9, v8
    v_lshl_add_u32 v8, v5, 4, v8
    v_add_u32 v114, s41, v8
    v_lshrrev_b32 v8, 3, v5
    v_lshl_add_u32 v8, v8, 3, v6
    v_mul_u32_u24 v8, 1152, v8
    v_add3_u32 v8, v8, v13, s41
    v_add_u32 v116, 1024, v8
    s_waitcnt lgkmcnt(0)
    s_add_u32 s8, s4, s60
    s_addc_u32 s9, s5, 0
    s_mov_b32 s10, 0x240000
    s_mov_b32 s11, 0x00020000
    s_add_u32 s24, s4, s61
    s_addc_u32 s25, s5, 0
    s_mov_b32 s26, 0x240000
    s_mov_b32 s27, 0x00020000
    s_add_u32 s56, s4, s63
    s_addc_u32 s57, s5, 0
    s_mov_b32 s58, 0x40000
    s_mov_b32 s59, 0x00020000
    s_mov_b32 s42, 0x3f803f80
    s_cmp_eq_u32 s37, 1
    s_cbranch_scc1 L_L_outA_ch11
    s_barrier
    s_barrier
    ds_read_b128 v[60:63], v108 offset:0
    ds_read_b128 v[52:55], v114 offset:0
    ds_read_b128 v[56:59], v114 offset:256
    ds_read_b128 v[64:67], v108 offset:1024
    ds_read_b128 v[68:71], v109 offset:8192
    ds_read_b128 v[80:83], v108 offset:4096
    ds_read_b128 v[72:75], v114 offset:2304
    ds_read_b128 v[76:79], v114 offset:2560
    ds_read_b128 v[84:87], v108 offset:5120
    ds_read_b128 v[88:91], v109 offset:8704
    s_waitcnt lgkmcnt(5)
    v_mfma_f32_16x16x32_bf16 v[16:19], v[60:63], v[52:55], 0
    v_mfma_f32_16x16x32_bf16 v[28:31], v[60:63], v[56:59], 0
    v_mfma_f32_16x16x32_bf16 v[20:23], v[64:67], v[52:55], 0
    v_mfma_f32_16x16x32_bf16 v[32:35], v[64:67], v[56:59], 0
    v_mfma_f32_16x16x32_bf16 v[24:27], v[68:71], v[52:55], 0
    v_mfma_f32_16x16x32_bf16 v[36:39], v[68:71], v[56:59], 0
    ds_read_b128 v[60:63], v108 offset:9216
    ds_read_b128 v[52:55], v114 offset:4608
    ds_read_b128 v[56:59], v114 offset:4864
    ds_read_b128 v[64:67], v108 offset:10240
    ds_read_b128 v[68:71], v109 offset:17408
    s_waitcnt lgkmcnt(5)
    v_mfma_f32_16x16x32_bf16 v[16:19], v[80:83], v[72:75], v[16:19]
    v_mfma_f32_16x16x32_bf16 v[28:31], v[80:83], v[76:79], v[28:31]
    v_mfma_f32_16x16x32_bf16 v[20:23], v[84:87], v[72:75], v[20:23]
    v_mfma_f32_16x16x32_bf16 v[32:35], v[84:87], v[76:79], v[32:35]
    v_mfma_f32_16x16x32_bf16 v[24:27], v[88:91], v[72:75], v[24:27]
    v_mfma_f32_16x16x32_bf16 v[36:39], v[88:91], v[76:79], v[36:39]
    ds_read_b128 v[80:83], v108 offset:13312
    ds_read_b128 v[72:75], v114 offset:6912
    ds_read_b128 v[76:79], v114 offset:7168
    ds_read_b128 v[84:87], v108 offset:14336
    ds_read_b128 v[88:91], v109 offset:17920
    s_waitcnt lgkmcnt(5)
    v_mfma_f32_16x16x32_bf16 v[16:19], v[60:63], v[52:55], v[16:19]
    v_mfma_f32_16x16x32_bf16 v[28:31], v[60:63], v[56:59], v[28:31]
    v_mfma_f32_16x16x32_bf16 v[20:23], v[64:67], v[52:55], v[20:23]
    v_mfma_f32_16x16x32_bf16 v[32:35], v[64:67], v[56:59], v[32:35]
    v_mfma_f32_16x16x32_bf16 v[24:27], v[68:71], v[52:55], v[24:27]
    v_mfma_f32_16x16x32_bf16 v[36:39], v[68:71], v[56:59], v[36:39]
    s_waitcnt lgkmcnt(0)
    v_mfma_f32_16x16x32_bf16 v[16:19], v[80:83], v[72:75], v[16:19]
    v_mfma_f32_16x16x32_bf16 v[28:31], v[80:83], v[76:79], v[28:31]
    v_mfma_f32_16x16x32_bf16 v[20:23], v[84:87], v[72:75], v[20:23]
    v_mfma_f32_16x16x32_bf16 v[32:35], v[84:87], v[76:79], v[32:35]
    v_mfma_f32_16x16x32_bf16 v[24:27], v[88:91], v[72:75], v[24:27]
    v_mfma_f32_16x16x32_bf16 v[36:39], v[88:91], v[76:79], v[36:39]
    s_barrier
    ds_read_b128 v[60:63], v108 offset:18432
    ds_read_b128 v[52:55], v114 offset:9216
    ds_read_b128 v[56:59], v114 offset:9472
    ds_read_b128 v[64:67], v108 offset:19456
    ds_read_b128 v[68:71], v109 offset:26624
    ds_read_b128 v[80:83], v108 offset:22528
    ds_read_b128 v[72:75], v114 offset:11520
    ds_read_b128 v[76:79], v114 offset:11776
    ds_read_b128 v[84:87], v108 offset:23552
    ds_read_b128 v[88:91], v109 offset:27136
    s_waitcnt lgkmcnt(5)
    v_mfma_f32_16x16x32_bf16 v[16:19], v[60:63], v[52:55], v[16:19]
    v_mfma_f32_16x16x32_bf16 v[28:31], v[60:63], v[56:59], v[28:31]
    v_mfma_f32_16x16x32_bf16 v[20:23], v[64:67], v[52:55], v[20:23]
    v_mfma_f32_16x16x32_bf16 v[32:35], v[64:67], v[56:59], v[32:35]
    v_mfma_f32_16x16x32_bf16 v[24:27], v[68:71], v[52:55], v[24:27]
    v_mfma_f32_16x16x32_bf16 v[36:39], v[68:71], v[56:59], v[36:39]
    ds_read_b128 v[60:63], v108 offset:27648
    ds_read_b128 v[52:55], v114 offset:13824
    ds_read_b128 v[56:59], v114 offset:14080
    ds_read_b128 v[64:67], v108 offset:28672
    ds_read_b128 v[68:71], v109 offset:35840
    s_waitcnt lgkmcnt(5)
    v_mfma_f32_16x16x32_bf16 v[16:19], v[80:83], v[72:75], v[16:19]
    v_mfma_f32_16x16x32_bf16 v[28:31], v[80:83], v[76:79], v[28:31]
    v_mfma_f32_16x16x32_bf16 v[20:23], v[84:87], v[72:75], v[20:23]
    v_mfma_f32_16x16x32_bf16 v[32:35], v[84:87], v[76:79], v[32:35]
    v_mfma_f32_16x16x32_bf16 v[24:27], v[88:91], v[72:75], v[24:27]
    v_mfma_f32_16x16x32_bf16 v[36:39], v[88:91], v[76:79], v[36:39]
    ds_read_b128 v[80:83], v108 offset:31744
    ds_read_b128 v[72:75], v114 offset:16128
    ds_read_b128 v[76:79], v114 offset:16384
    ds_read_b128 v[84:87], v108 offset:32768
    ds_read_b128 v[88:91], v109 offset:36352
    s_waitcnt lgkmcnt(5)
    v_mfma_f32_16x16x32_bf16 v[16:19], v[60:63], v[52:55], v[16:19]
    v_mfma_f32_16x16x32_bf16 v[28:31], v[60:63], v[56:59], v[28:31]
    v_mfma_f32_16x16x32_bf16 v[20:23], v[64:67], v[52:55], v[20:23]
    v_mfma_f32_16x16x32_bf16 v[32:35], v[64:67], v[56:59], v[32:35]
    v_mfma_f32_16x16x32_bf16 v[24:27], v[68:71], v[52:55], v[24:27]
    v_mfma_f32_16x16x32_bf16 v[36:39], v[68:71], v[56:59], v[36:39]
    s_waitcnt lgkmcnt(0)
    v_mfma_f32_16x16x32_bf16 v[16:19], v[80:83], v[72:75], v[16:19]
    v_mfma_f32_16x16x32_bf16 v[28:31], v[80:83], v[76:79], v[28:31]
    v_mfma_f32_16x16x32_bf16 v[20:23], v[84:87], v[72:75], v[20:23]
    v_mfma_f32_16x16x32_bf16 v[32:35], v[84:87], v[76:79], v[32:35]
    v_mfma_f32_16x16x32_bf16 v[24:27], v[88:91], v[72:75], v[24:27]
    v_mfma_f32_16x16x32_bf16 v[36:39], v[88:91], v[76:79], v[36:39]
    buffer_load_dwordx4 v[40:43], v110, s[8:11], 0 offen offset:0
    buffer_load_dwordx2 v[44:45], v111, s[8:11], 0 offen offset:0
    buffer_load_dwordx4 v[46:49], v110, s[8:11], 0 offen offset:256
    buffer_load_dwordx2 v[50:51], v111, s[8:11], 0 offen offset:256
    s_barrier
    ds_read_b128 v[60:63], v108 offset:36864
    ds_read_b128 v[52:55], v114 offset:18432
    ds_read_b128 v[56:59], v114 offset:18688
    ds_read_b128 v[64:67], v108 offset:37888
    ds_read_b128 v[68:71], v109 offset:45056
    ds_read_b128 v[80:83], v108 offset:40960
    ds_read_b128 v[72:75], v114 offset:20736
    ds_read_b128 v[76:79], v114 offset:20992
    ds_read_b128 v[84:87], v108 offset:41984
    ds_read_b128 v[88:91], v109 offset:45568
    s_waitcnt lgkmcnt(5)
    v_mfma_f32_16x16x32_bf16 v[16:19], v[60:63], v[52:55], v[16:19]
    v_mfma_f32_16x16x32_bf16 v[28:31], v[60:63], v[56:59], v[28:31]
    v_mfma_f32_16x16x32_bf16 v[20:23], v[64:67], v[52:55], v[20:23]
    v_mfma_f32_16x16x32_bf16 v[32:35], v[64:67], v[56:59], v[32:35]
    v_mfma_f32_16x16x32_bf16 v[24:27], v[68:71], v[52:55], v[24:27]
    v_mfma_f32_16x16x32_bf16 v[36:39], v[68:71], v[56:59], v[36:39]
    v_add_u32 v108, 46080, v108
    v_add_u32 v109, 46080, v109
    ds_read_b128 v[60:63], v108 offset:0
    ds_read_b128 v[52:55], v114 offset:23040
    ds_read_b128 v[56:59], v114 offset:23296
    ds_read_b128 v[64:67], v108 offset:1024
    ds_read_b128 v[68:71], v109 offset:8192
    s_waitcnt lgkmcnt(5)
    v_mfma_f32_16x16x32_bf16 v[16:19], v[80:83], v[72:75], v[16:19]
    v_mfma_f32_16x16x32_bf16 v[28:31], v[80:83], v[76:79], v[28:31]
    v_mfma_f32_16x16x32_bf16 v[20:23], v[84:87], v[72:75], v[20:23]
    v_mfma_f32_16x16x32_bf16 v[32:35], v[84:87], v[76:79], v[32:35]
    v_mfma_f32_16x16x32_bf16 v[24:27], v[88:91], v[72:75], v[24:27]
    v_mfma_f32_16x16x32_bf16 v[36:39], v[88:91], v[76:79], v[36:39]
    ds_read_b128 v[80:83], v108 offset:4096
    ds_read_b128 v[72:75], v114 offset:25344
    ds_read_b128 v[76:79], v114 offset:25600
    ds_read_b128 v[84:87], v108 offset:5120
    ds_read_b128 v[88:91], v109 offset:8704
    s_waitcnt lgkmcnt(5)
    v_mfma_f32_16x16x32_bf16 v[16:19], v[60:63], v[52:55], v[16:19]
    v_mfma_f32_16x16x32_bf16 v[28:31], v[60:63], v[56:59], v[28:31]
    v_mfma_f32_16x16x32_bf16 v[20:23], v[64:67], v[52:55], v[20:23]
    v_mfma_f32_16x16x32_bf16 v[32:35], v[64:67], v[56:59], v[32:35]
    v_mfma_f32_16x16x32_bf16 v[24:27], v[68:71], v[52:55], v[24:27]
    v_mfma_f32_16x16x32_bf16 v[36:39], v[68:71], v[56:59], v[36:39]
    s_waitcnt lgkmcnt(0)
    v_mfma_f32_16x16x32_bf16 v[16:19], v[80:83], v[72:75], v[16:19]
    v_mfma_f32_16x16x32_bf16 v[28:31], v[80:83], v[76:79], v[28:31]
    v_mfma_f32_16x16x32_bf16 v[20:23], v[84:87], v[72:75], v[20:23]
    v_mfma_f32_16x16x32_bf16 v[32:35], v[84:87], v[76:79], v[32:35]
    v_mfma_f32_16x16x32_bf16 v[24:27], v[88:91], v[72:75], v[24:27]
    v_mfma_f32_16x16x32_bf16 v[36:39], v[88:91], v[76:79], v[36:39]
    s_barrier
    ds_read_b128 v[60:63], v108 offset:9216
    ds_read_b128 v[52:55], v114 offset:27648
    ds_read_b128 v[56:59], v114 offset:27904
    ds_read_b128 v[64:67], v108 offset:10240
    ds_read_b128 v[68:71], v109 offset:17408
    ds_read_b128 v[80:83], v108 offset:13312
    ds_read_b128 v[72:75], v114 offset:29952
    ds_read_b128 v[76:79], v114 offset:30208
    ds_read_b128 v[84:87], v108 offset:14336
    ds_read_b128 v[88:91], v109 offset:17920
    s_waitcnt lgkmcnt(5)
    v_mfma_f32_16x16x32_bf16 v[16:19], v[60:63], v[52:55], v[16:19]
    v_mfma_f32_16x16x32_bf16 v[28:31], v[60:63], v[56:59], v[28:31]
    v_mfma_f32_16x16x32_bf16 v[20:23], v[64:67], v[52:55], v[20:23]
    v_mfma_f32_16x16x32_bf16 v[32:35], v[64:67], v[56:59], v[32:35]
    v_mfma_f32_16x16x32_bf16 v[24:27], v[68:71], v[52:55], v[24:27]
    v_mfma_f32_16x16x32_bf16 v[36:39], v[68:71], v[56:59], v[36:39]
    ds_read_b128 v[60:63], v108 offset:18432
    ds_read_b128 v[52:55], v114 offset:32256
    ds_read_b128 v[56:59], v114 offset:32512
    ds_read_b128 v[64:67], v108 offset:19456
    ds_read_b128 v[68:71], v109 offset:26624
    s_waitcnt lgkmcnt(5)
    v_mfma_f32_16x16x32_bf16 v[16:19], v[80:83], v[72:75], v[16:19]
    v_mfma_f32_16x16x32_bf16 v[28:31], v[80:83], v[76:79], v[28:31]
    v_mfma_f32_16x16x32_bf16 v[20:23], v[84:87], v[72:75], v[20:23]
    v_mfma_f32_16x16x32_bf16 v[32:35], v[84:87], v[76:79], v[32:35]
    v_mfma_f32_16x16x32_bf16 v[24:27], v[88:91], v[72:75], v[24:27]
    v_mfma_f32_16x16x32_bf16 v[36:39], v[88:91], v[76:79], v[36:39]
    ds_read_b128 v[80:83], v108 offset:22528
    ds_read_b128 v[72:75], v114 offset:34560
    ds_read_b128 v[76:79], v114 offset:34816
    ds_read_b128 v[84:87], v108 offset:23552
    ds_read_b128 v[88:91], v109 offset:27136
    s_waitcnt lgkmcnt(5)
    v_mfma_f32_16x16x32_bf16 v[16:19], v[60:63], v[52:55], v[16:19]
    v_mfma_f32_16x16x32_bf16 v[28:31], v[60:63], v[56:59], v[28:31]
    v_mfma_f32_16x16x32_bf16 v[20:23], v[64:67], v[52:55], v[20:23]
    v_mfma_f32_16x16x32_bf16 v[32:35], v[64:67], v[56:59], v[32:35]
    v_mfma_f32_16x16x32_bf16 v[24:27], v[68:71], v[52:55], v[24:27]
    v_mfma_f32_16x16x32_bf16 v[36:39], v[68:71], v[56:59], v[36:39]
    s_waitcnt lgkmcnt(0)
    v_mfma_f32_16x16x32_bf16 v[16:19], v[80:83], v[72:75], v[16:19]
    v_mfma_f32_16x16x32_bf16 v[28:31], v[80:83], v[76:79], v[28:31]
    v_mfma_f32_16x16x32_bf16 v[20:23], v[84:87], v[72:75], v[20:23]
    v_mfma_f32_16x16x32_bf16 v[32:35], v[84:87], v[76:79], v[32:35]
    v_mfma_f32_16x16x32_bf16 v[24:27], v[88:91], v[72:75], v[24:27]
    v_mfma_f32_16x16x32_bf16 v[36:39], v[88:91], v[76:79], v[36:39]
    s_waitcnt vmcnt(0)
    v_lshlrev_b32 v92, 16, v40
    v_and_b32 v93, 0xffff0000, v40
    v_lshlrev_b32 v94, 16, v41
    v_and_b32 v95, 0xffff0000, v41
    v_lshlrev_b32 v96, 16, v42
    v_and_b32 v97, 0xffff0000, v42
    v_lshlrev_b32 v98, 16, v43
    v_and_b32 v99, 0xffff0000, v43
    v_lshlrev_b32 v100, 16, v44
    v_and_b32 v101, 0xffff0000, v44
    v_lshlrev_b32 v102, 16, v45
    v_and_b32 v103, 0xffff0000, v45
    s_barrier
    ds_read_b128 v[60:63], v108 offset:27648
    ds_read_b128 v[52:55], v116 offset:0
    ds_read_b128 v[56:59], v116 offset:18432
    ds_read_b128 v[64:67], v108 offset:28672
    ds_read_b128 v[68:71], v109 offset:35840
    ds_read_b128 v[80:83], v108 offset:31744
    ds_read_b128 v[72:75], v116 offset:4608
    ds_read_b128 v[76:79], v116 offset:23040
    ds_read_b128 v[84:87], v108 offset:32768
    ds_read_b128 v[88:91], v109 offset:36352
    s_waitcnt lgkmcnt(5)
    v_mfma_f32_16x16x32_bf16 v[16:19], v[60:63], v[52:55], v[16:19]
    v_mfma_f32_16x16x32_bf16 v[28:31], v[60:63], v[56:59], v[28:31]
    v_mfma_f32_16x16x32_bf16 v[20:23], v[64:67], v[52:55], v[20:23]
    v_mfma_f32_16x16x32_bf16 v[32:35], v[64:67], v[56:59], v[32:35]
    v_mfma_f32_16x16x32_bf16 v[24:27], v[68:71], v[52:55], v[24:27]
    v_mfma_f32_16x16x32_bf16 v[36:39], v[68:71], v[56:59], v[36:39]
    s_waitcnt lgkmcnt(0)
    v_mfma_f32_16x16x32_bf16 v[16:19], v[80:83], v[72:75], v[16:19]
    v_mfma_f32_16x16x32_bf16 v[28:31], v[80:83], v[76:79], v[28:31]
    v_mfma_f32_16x16x32_bf16 v[20:23], v[84:87], v[72:75], v[20:23]
    v_mfma_f32_16x16x32_bf16 v[32:35], v[84:87], v[76:79], v[32:35]
    v_mfma_f32_16x16x32_bf16 v[24:27], v[88:91], v[72:75], v[24:27]
    v_mfma_f32_16x16x32_bf16 v[36:39], v[88:91], v[76:79], v[36:39]
    v_lshlrev_b32 v52, 16, v46
    v_and_b32 v53, 0xffff0000, v46
    v_lshlrev_b32 v54, 16, v47
    v_and_b32 v55, 0xffff0000, v47
    v_lshlrev_b32 v56, 16, v48
    v_and_b32 v57, 0xffff0000, v48
    v_lshlrev_b32 v58, 16, v49
    v_and_b32 v59, 0xffff0000, v49
    v_lshlrev_b32 v60, 16, v50
    v_and_b32 v61, 0xffff0000, v50
    v_lshlrev_b32 v62, 16, v51
    v_and_b32 v63, 0xffff0000, v51
    v_mov_b32 v8, 0
    v_mov_b32 v9, 0
    v_mov_b32 v10, 0
    v_mov_b32 v11, 0
    v_permlane16_swap_b32 v16, v20
    v_permlane16_swap_b32 v17, v21
    v_permlane16_swap_b32 v18, v22
    v_permlane16_swap_b32 v19, v23
    v_pk_add_f32 v[24:25], v[24:25], v[100:101]
    v_pk_add_f32 v[26:27], v[26:27], v[102:103]
    v_pk_add_f32 v[16:17], v[16:17], v[92:93]
    v_pk_add_f32 v[18:19], v[18:19], v[94:95]
    v_pk_add_f32 v[20:21], v[20:21], v[96:97]
    v_pk_add_f32 v[22:23], v[22:23], v[98:99]
    v_cvt_pk_bf16_f32 v72, v16, v17
    v_cvt_pk_bf16_f32 v73, v18, v19
    v_cvt_pk_bf16_f32 v74, v20, v21
    v_cvt_pk_bf16_f32 v75, v22, v23
    v_cvt_pk_bf16_f32 v76, v24, v25
    v_cvt_pk_bf16_f32 v77, v26, v27
    buffer_store_dwordx4 v[72:75], v110, s[24:27], 0 offen
    buffer_store_dwordx2 v[76:77], v111, s[24:27], 0 offen
    v_cndmask_b32 v78, 0, v76, s[48:49]
    v_cndmask_b32 v79, 0, v77, s[48:49]
    v_permlane16_swap_b32 v28, v32
    v_permlane16_swap_b32 v29, v33
    v_permlane16_swap_b32 v30, v34
    v_permlane16_swap_b32 v31, v35
    v_pk_add_f32 v[36:37], v[36:37], v[60:61]
    v_pk_add_f32 v[38:39], v[38:39], v[62:63]
    v_pk_add_f32 v[28:29], v[28:29], v[52:53]
    v_pk_add_f32 v[30:31], v[30:31], v[54:55]
    v_pk_add_f32 v[32:33], v[32:33], v[56:57]
    v_pk_add_f32 v[34:35], v[34:35], v[58:59]
    v_cvt_pk_bf16_f32 v80, v28, v29
    v_cvt_pk_bf16_f32 v81, v30, v31
    v_cvt_pk_bf16_f32 v82, v32, v33
    v_cvt_pk_bf16_f32 v83, v34, v35
    v_cvt_pk_bf16_f32 v84, v36, v37
    v_cvt_pk_bf16_f32 v85, v38, v39
    buffer_store_dwordx4 v[80:83], v110, s[24:27], s43 offen
    buffer_store_dwordx2 v[84:85], v111, s[24:27], s43 offen
    v_cndmask_b32 v86, 0, v84, s[48:49]
    v_cndmask_b32 v87, 0, v85, s[48:49]
    v_dot2_f32_bf16 v8, v72, s42, v8
    v_dot2_f32_bf16 v9, v72, v72, v9
    v_dot2_f32_bf16 v10, v80, s42, v10
    v_dot2_f32_bf16 v11, v80, v80, v11
    v_dot2_f32_bf16 v8, v73, s42, v8
    v_dot2_f32_bf16 v9, v73, v73, v9
    v_dot2_f32_bf16 v10, v81, s42, v10
    v_dot2_f32_bf16 v11, v81, v81, v11
    v_dot2_f32_bf16 v8, v74, s42, v8
    v_dot2_f32_bf16 v9, v74, v74, v9
    v_dot2_f32_bf16 v10, v82, s42, v10
    v_dot2_f32_bf16 v11, v82, v82, v11
    v_dot2_f32_bf16 v8, v75, s42, v8
    v_dot2_f32_bf16 v9, v75, v75, v9
    v_dot2_f32_bf16 v10, v83, s42, v10
    v_dot2_f32_bf16 v11, v83, v83, v11
    v_dot2_f32_bf16 v8, v78, s42, v8
    v_dot2_f32_bf16 v9, v78, v78, v9
    v_dot2_f32_bf16 v10, v86, s42, v10
    v_dot2_f32_bf16 v11, v86, v86, v11
    v_dot2_f32_bf16 v8, v79, s42, v8
    v_dot2_f32_bf16 v9, v79, v79, v9
    v_dot2_f32_bf16 v10, v87, s42, v10
    v_dot2_f32_bf16 v11, v87, v87, v11
    s_nop 2
    v_permlane16_swap_b32 v8, v10
    v_permlane16_swap_b32 v9, v11
    s_nop 1
    v_pk_add_f32 v[8:9], v[8:9], v[10:11]
    s_nop 0
    v_mov_b32 v10, v8
    v_mov_b32 v11, v9
    s_nop 1
    v_permlane32_swap_b32 v10, v8
    v_permlane32_swap_b32 v11, v9
    s_nop 1
    v_pk_add_f32 v[8:9], v[8:9], v[10:11]
    buffer_store_dwordx2 v[8:9], v115, s[56:59], s39 offen
    s_endpgm
L_L_outA_ch11:
    s_barrier
    s_barrier
    ds_read_b128 v[60:63], v108 offset:0
    ds_read_b128 v[52:55], v114 offset:0
    ds_read_b128 v[56:59], v114 offset:256
    ds_read_b128 v[64:67], v108 offset:1024
    ds_read_b128 v[80:83], v108 offset:4096
    ds_read_b128 v[72:75], v114 offset:2304
    ds_read_b128 v[76:79], v114 offset:2560
    ds_read_b128 v[84:87], v108 offset:5120
    s_waitcnt lgkmcnt(4)
    v_mfma_f32_16x16x32_bf16 v[16:19], v[60:63], v[52:55], 0
    v_mfma_f32_16x16x32_bf16 v[28:31], v[60:63], v[56:59], 0
    v_mfma_f32_16x16x32_bf16 v[20:23], v[64:67], v[52:55], 0
    v_mfma_f32_16x16x32_bf16 v[32:35], v[64:67], v[56:59], 0
    ds_read_b128 v[60:63], v108 offset:9216
    ds_read_b128 v[52:55], v114 offset:4608
    ds_read_b128 v[56:59], v114 offset:4864
    ds_read_b128 v[64:67], v108 offset:10240
    s_waitcnt lgkmcnt(4)
    v_mfma_f32_16x16x32_bf16 v[16:19], v[80:83], v[72:75], v[16:19]
    v_mfma_f32_16x16x32_bf16 v[28:31], v[80:83], v[76:79], v[28:31]
    v_mfma_f32_16x16x32_bf16 v[20:23], v[84:87], v[72:75], v[20:23]
    v_mfma_f32_16x16x32_bf16 v[32:35], v[84:87], v[76:79], v[32:35]
    ds_read_b128 v[80:83], v108 offset:13312
    ds_read_b128 v[72:75], v114 offset:6912
    ds_read_b128 v[76:79], v114 offset:7168
    ds_read_b128 v[84:87], v108 offset:14336
    s_waitcnt lgkmcnt(4)
    v_mfma_f32_16x16x32_bf16 v[16:19], v[60:63], v[52:55], v[16:19]
    v_mfma_f32_16x16x32_bf16 v[28:31], v[60:63], v[56:59], v[28:31]
    v_mfma_f32_16x16x32_bf16 v[20:23], v[64:67], v[52:55], v[20:23]
    v_mfma_f32_16x16x32_bf16 v[32:35], v[64:67], v[56:59], v[32:35]
    s_waitcnt lgkmcnt(0)
    v_mfma_f32_16x16x32_bf16 v[16:19], v[80:83], v[72:75], v[16:19]
    v_mfma_f32_16x16x32_bf16 v[28:31], v[80:83], v[76:79], v[28:31]
    v_mfma_f32_16x16x32_bf16 v[20:23], v[84:87], v[72:75], v[20:23]
    v_mfma_f32_16x16x32_bf16 v[32:35], v[84:87], v[76:79], v[32:35]
    s_barrier
    ds_read_b128 v[60:63], v108 offset:18432
    ds_read_b128 v[52:55], v114 offset:9216
    ds_read_b128 v[56:59], v114 offset:9472
    ds_read_b128 v[64:67], v108 offset:19456
    ds_read_b128 v[80:83], v108 offset:22528
    ds_read_b128 v[72:75], v114 offset:11520
    ds_read_b128 v[76:79], v114 offset:11776
    ds_read_b128 v[84:87], v108 offset:23552
    s_waitcnt lgkmcnt(4)
    v_mfma_f32_16x16x32_bf16 v[16:19], v[60:63], v[52:55], v[16:19]
    v_mfma_f32_16x16x32_bf16 v[28:31], v[60:63], v[56:59], v[28:31]
    v_mfma_f32_16x16x32_bf16 v[20:23], v[64:67], v[52:55], v[20:23]
    v_mfma_f32_16x16x32_bf16 v[32:35], v[64:67], v[56:59], v[32:35]
    ds_read_b128 v[60:63], v108 offset:27648
    ds_read_b128 v[52:55], v114 offset:13824
    ds_read_b128 v[56:59], v114 offset:14080
    ds_read_b128 v[64:67], v108 offset:28672
    s_waitcnt lgkmcnt(4)
    v_mfma_f32_16x16x32_bf16 v[16:19], v[80:83], v[72:75], v[16:19]
    v_mfma_f32_16x16x32_bf16 v[28:31], v[80:83], v[76:79], v[28:31]
    v_mfma_f32_16x16x32_bf16 v[20:23], v[84:87], v[72:75], v[20:23]
    v_mfma_f32_16x16x32_bf16 v[32:35], v[84:87], v[76:79], v[32:35]
    ds_read_b128 v[80:83], v108 offset:31744
    ds_read_b128 v[72:75], v114 offset:16128
    ds_read_b128 v[76:79], v114 offset:16384
    ds_read_b128 v[84:87], v108 offset:32768
    s_waitcnt lgkmcnt(4)
    v_mfma_f32_16x16x32_bf16 v[16:19], v[60:63], v[52:55], v[16:19]
    v_mfma_f32_16x16x32_bf16 v[28:31], v[60:63], v[56:59], v[28:31]
    v_mfma_f32_16x16x32_bf16 v[20:23], v[64:67], v[52:55], v[20:23]
    v_mfma_f32_16x16x32_bf16 v[32:35], v[64:67], v[56:59], v[32:35]
    s_waitcnt lgkmcnt(0)
    v_mfma_f32_16x16x32_bf16 v[16:19], v[80:83], v[72:75], v[16:19]
    v_mfma_f32_16x16x32_bf16 v[28:31], v[80:83], v[76:79], v[28:31]
    v_mfma_f32_16x16x32_bf16 v[20:23], v[84:87], v[72:75], v[20:23]
    v_mfma_f32_16x16x32_bf16 v[32:35], v[84:87], v[76:79], v[32:35]
    buffer_load_dwordx4 v[40:43], v110, s[8:11], 0 offen offset:0
    buffer_load_dwordx4 v[46:49], v110, s[8:11], 0 offen offset:256
    s_barrier
    ds_read_b128 v[60:63], v108 offset:36864
    ds_read_b128 v[52:55], v114 offset:18432
    ds_read_b128 v[56:59], v114 offset:18688
    ds_read_b128 v[64:67], v108 offset:37888
    ds_read_b128 v[80:83], v108 offset:40960
    ds_read_b128 v[72:75], v114 offset:20736
    ds_read_b128 v[76:79], v114 offset:20992
    ds_read_b128 v[84:87], v108 offset:41984
    s_waitcnt lgkmcnt(4)
    v_mfma_f32_16x16x32_bf16 v[16:19], v[60:63], v[52:55], v[16:19]
    v_mfma_f32_16x16x32_bf16 v[28:31], v[60:63], v[56:59], v[28:31]
    v_mfma_f32_16x16x32_bf16 v[20:23], v[64:67], v[52:55], v[20:23]
    v_mfma_f32_16x16x32_bf16 v[32:35], v[64:67], v[56:59], v[32:35]
    v_add_u32 v108, 46080, v108
    v_add_u32 v109, 46080, v109
    ds_read_b128 v[60:63], v108 offset:0
    ds_read_b128 v[52:55], v114 offset:23040
    ds_read_b128 v[56:59], v114 offset:23296
    ds_read_b128 v[64:67], v108 offset:1024
    s_waitcnt lgkmcnt(4)
    v_mfma_f32_16x16x32_bf16 v[16:19], v[80:83], v[72:75], v[16:19]
    v_mfma_f32_16x16x32_bf16 v[28:31], v[80:83], v[76:79], v[28:31]
    v_mfma_f32_16x16x32_bf16 v[20:23], v[84:87], v[72:75], v[20:23]
    v_mfma_f32_16x16x32_bf16 v[32:35], v[84:87], v[76:79], v[32:35]
    ds_read_b128 v[80:83], v108 offset:4096
    ds_read_b128 v[72:75], v114 offset:25344
    ds_read_b128 v[76:79], v114 offset:25600
    ds_read_b128 v[84:87], v108 offset:5120
    s_waitcnt lgkmcnt(4)
    v_mfma_f32_16x16x32_bf16 v[16:19], v[60:63], v[52:55], v[16:19]
    v_mfma_f32_16x16x32_bf16 v[28:31], v[60:63], v[56:59], v[28:31]
    v_mfma_f32_16x16x32_bf16 v[20:23], v[64:67], v[52:55], v[20:23]
    v_mfma_f32_16x16x32_bf16 v[32:35], v[64:67], v[56:59], v[32:35]
    s_waitcnt lgkmcnt(0)
    v_mfma_f32_16x16x32_bf16 v[16:19], v[80:83], v[72:75], v[16:19]
    v_mfma_f32_16x16x32_bf16 v[28:31], v[80:83], v[76:79], v[28:31]
    v_mfma_f32_16x16x32_bf16 v[20:23], v[84:87], v[72:75], v[20:23]
    v_mfma_f32_16x16x32_bf16 v[32:35], v[84:87], v[76:79], v[32:35]
    s_barrier
    ds_read_b128 v[60:63], v108 offset:9216
    ds_read_b128 v[52:55], v114 offset:27648
    ds_read_b128 v[56:59], v114 offset:27904
    ds_read_b128 v[64:67], v108 offset:10240
    ds_read_b128 v[80:83], v108 offset:13312
    ds_read_b128 v[72:75], v114 offset:29952
    ds_read_b128 v[76:79], v114 offset:30208
    ds_read_b128 v[84:87], v108 offset:14336
    s_waitcnt lgkmcnt(4)
    v_mfma_f32_16x16x32_bf16 v[16:19], v[60:63], v[52:55], v[16:19]
    v_mfma_f32_16x16x32_bf16 v[28:31], v[60:63], v[56:59], v[28:31]
    v_mfma_f32_16x16x32_bf16 v[20:23], v[64:67], v[52:55], v[20:23]
    v_mfma_f32_16x16x32_bf16 v[32:35], v[64:67], v[56:59], v[32:35]
    ds_read_b128 v[60:63], v108 offset:18432
    ds_read_b128 v[52:55], v114 offset:32256
    ds_read_b128 v[56:59], v114 offset:32512
    ds_read_b128 v[64:67], v108 offset:19456
    s_waitcnt lgkmcnt(4)
    v_mfma_f32_16x16x32_bf16 v[16:19], v[80:83], v[72:75], v[16:19]
    v_mfma_f32_16x16x32_bf16 v[28:31], v[80:83], v[76:79], v[28:31]
    v_mfma_f32_16x16x32_bf16 v[20:23], v[84:87], v[72:75], v[20:23]
    v_mfma_f32_16x16x32_bf16 v[32:35], v[84:87], v[76:79], v[32:35]
    ds_read_b128 v[80:83], v108 offset:22528
    ds_read_b128 v[72:75], v114 offset:34560
    ds_read_b128 v[76:79], v114 offset:34816
    ds_read_b128 v[84:87], v108 offset:23552
    s_waitcnt lgkmcnt(4)
    v_mfma_f32_16x16x32_bf16 v[16:19], v[60:63], v[52:55], v[16:19]
    v_mfma_f32_16x16x32_bf16 v[28:31], v[60:63], v[56:59], v[28:31]
    v_mfma_f32_16x16x32_bf16 v[20:23], v[64:67], v[52:55], v[20:23]
    v_mfma_f32_16x16x32_bf16 v[32:35], v[64:67], v[56:59], v[32:35]
    s_waitcnt lgkmcnt(0)
    v_mfma_f32_16x16x32_bf16 v[16:19], v[80:83], v[72:75], v[16:19]
    v_mfma_f32_16x16x32_bf16 v[28:31], v[80:83], v[76:79], v[28:31]
    v_mfma_f32_16x16x32_bf16 v[20:23], v[84:87], v[72:75], v[20:23]
    v_mfma_f32_16x16x32_bf16 v[32:35], v[84:87], v[76:79], v[32:35]
    s_waitcnt vmcnt(0)
    v_lshlrev_b32 v92, 16, v40
    v_and_b32 v93, 0xffff0000, v40
    v_lshlrev_b32 v94, 16, v41
    v_and_b32 v95, 0xffff0000, v41
    v_lshlrev_b32 v96, 16, v42
    v_and_b32 v97, 0xffff0000, v42
    v_lshlrev_b32 v98, 16, v43
    v_and_b32 v99, 0xffff0000, v43
    s_barrier
    ds_read_b128 v[60:63], v108 offset:27648
    ds_read_b128 v[52:55], v116 offset:0
    ds_read_b128 v[56:59], v116 offset:18432
    ds_read_b128 v[64:67], v108 offset:28672
    ds_read_b128 v[80:83], v108 offset:31744
    ds_read_b128 v[72:75], v116 offset:4608
    ds_read_b128 v[76:79], v116 offset:23040
    ds_read_b128 v[84:87], v108 offset:32768
    s_waitcnt lgkmcnt(4)
    v_mfma_f32_16x16x32_bf16 v[16:19], v[60:63], v[52:55], v[16:19]
    v_mfma_f32_16x16x32_bf16 v[28:31], v[60:63], v[56:59], v[28:31]
    v_mfma_f32_16x16x32_bf16 v[20:23], v[64:67], v[52:55], v[20:23]
    v_mfma_f32_16x16x32_bf16 v[32:35], v[64:67], v[56:59], v[32:35]
    s_waitcnt lgkmcnt(0)
    v_mfma_f32_16x16x32_bf16 v[16:19], v[80:83], v[72:75], v[16:19]
    v_mfma_f32_16x16x32_bf16 v[28:31], v[80:83], v[76:79], v[28:31]
    v_mfma_f32_16x16x32_bf16 v[20:23], v[84:87], v[72:75], v[20:23]
    v_mfma_f32_16x16x32_bf16 v[32:35], v[84:87], v[76:79], v[32:35]
    v_lshlrev_b32 v52, 16, v46
    v_and_b32 v53, 0xffff0000, v46
    v_lshlrev_b32 v54, 16, v47
    v_and_b32 v55, 0xffff0000, v47
    v_lshlrev_b32 v56, 16, v48
    v_and_b32 v57, 0xffff0000, v48
    v_lshlrev_b32 v58, 16, v49
    v_and_b32 v59, 0xffff0000, v49
    v_mov_b32 v8, 0
    v_mov_b32 v9, 0
    v_mov_b32 v10, 0
    v_mov_b32 v11, 0
    v_permlane16_swap_b32 v16, v20
    v_permlane16_swap_b32 v17, v21
    v_permlane16_swap_b32 v18, v22
    v_permlane16_swap_b32 v19, v23
    s_nop 1
    v_pk_add_f32 v[16:17], v[16:17], v[92:93]
    v_pk_add_f32 v[18:19], v[18:19], v[94:95]
    v_pk_add_f32 v[20:21], v[20:21], v[96:97]
    v_pk_add_f32 v[22:23], v[22:23], v[98:99]
    v_cvt_pk_bf16_f32 v72, v16, v17
    v_cvt_pk_bf16_f32 v73, v18, v19
    v_cvt_pk_bf16_f32 v74, v20, v21
    v_cvt_pk_bf16_f32 v75, v22, v23
    buffer_store_dwordx4 v[72:75], v110, s[24:27], 0 offen
    v_permlane16_swap_b32 v28, v32
    v_permlane16_swap_b32 v29, v33
    v_permlane16_swap_b32 v30, v34
    v_permlane16_swap_b32 v31, v35
    s_nop 1
    v_pk_add_f32 v[28:29], v[28:29], v[52:53]
    v_pk_add_f32 v[30:31], v[30:31], v[54:55]
    v_pk_add_f32 v[32:33], v[32:33], v[56:57]
    v_pk_add_f32 v[34:35], v[34:35], v[58:59]
    v_cvt_pk_bf16_f32 v80, v28, v29
    v_cvt_pk_bf16_f32 v81, v30, v31
    v_cvt_pk_bf16_f32 v82, v32, v33
    v_cvt_pk_bf16_f32 v83, v34, v35
    buffer_store_dwordx4 v[80:83], v110, s[24:27], s43 offen
    v_dot2_f32_bf16 v8, v72, s42, v8
    v_dot2_f32_bf16 v9, v72, v72, v9
    v_dot2_f32_bf16 v10, v80, s42, v10
    v_dot2_f32_bf16 v11, v80, v80, v11
    v_dot2_f32_bf16 v8, v73, s42, v8
    v_dot2_f32_bf16 v9, v73, v73, v9
    v_dot2_f32_bf16 v10, v81, s42, v10
    v_dot2_f32_bf16 v11, v81, v81, v11
    v_dot2_f32_bf16 v8, v74, s42, v8
    v_dot2_f32_bf16 v9, v74, v74, v9
    v_dot2_f32_bf16 v10, v82, s42, v10
    v_dot2_f32_bf16 v11, v82, v82, v11
    v_dot2_f32_bf16 v8, v75, s42, v8
    v_dot2_f32_bf16 v9, v75, v75, v9
    v_dot2_f32_bf16 v10, v83, s42, v10
    v_dot2_f32_bf16 v11, v83, v83, v11
    s_nop 2
    v_permlane16_swap_b32 v8, v10
    v_permlane16_swap_b32 v9, v11
    s_nop 1
    v_pk_add_f32 v[8:9], v[8:9], v[10:11]
    s_nop 0
    v_mov_b32 v10, v8
    v_mov_b32 v11, v9
    s_nop 1
    v_permlane32_swap_b32 v10, v8
    v_permlane32_swap_b32 v11, v9
    s_nop 1
    v_pk_add_f32 v[8:9], v[8:9], v[10:11]
    buffer_store_dwordx2 v[8:9], v115, s[56:59], s39 offen
    s_endpgm
L_L_outA_st1:
    s_and_b32 s36, s35, 7
    v_and_b32 v1, 31, v3
    v_lshrrev_b32 v2, 5, v3
    s_mul_i32 s41, s36, 1408
    s_add_u32 s41, s41, 36864
    v_min_u32 v8, 18, v1
    v_mul_u32_u24 v8, 72, v8
    v_add_u32 v9, s41, v8
    v_lshl_add_u32 v8, v2, 5, v9
    s_mul_i32 s41, s36, 1152
    s_add_u32 s41, s41, 82944
    v_add_u32 v10, s41, v15
    v_add_u32 v6, 36864, v10
    v_lshl_add_u32 v11, v1, 2, s41
    v_add_u32 v11, 1024, v11
    v_add_u32 v7, 36864, v11
    v_lshrrev_b32 v12, 3, v1
    v_mul_u32_u24 v12, 9216, v12
    v_and_b32 v5, 7, v1
    v_lshl_add_u32 v12, v5, 4, v12
    v_add_u32 v12, s41, v12
    v_cmp_eq_u32 s[50:51], 0, v2
    v_mov_b32 v33, 0
    v_mov_b32 v34, 0
    v_mov_b32 v35, 0
    v_mov_b32 v48, 0
    v_mov_b32 v49, 0
    v_mov_b32 v50, 0
    v_mov_b32 v51, 0
    v_mov_b32 v41, 0
    v_mov_b32 v42, 0
    v_mov_b32 v43, 0
    v_mov_b32 v56, 0
    v_mov_b32 v57, 0
    v_mov_b32 v58, 0
    v_mov_b32 v59, 0
    s_mov_b32 s42, 0x358637bd
    s_barrier
    ds_read_b64 v[16:17], v8 offset:0
    ds_read_b64 v[18:19], v8 offset:8
    ds_read_b64 v[20:21], v8 offset:16
    ds_read_b64 v[22:23], v8 offset:24
    ds_read_b64 v[24:25], v9 offset:64
    ds_read_b128 v[44:47], v10 offset:0
    ds_read_b128 v[52:55], v6 offset:0
    s_mov_b64 exec, s[50:51]
    ds_read_b32 v48, v11 offset:0
    ds_read_b32 v56, v7 offset:0
    s_mov_b64 exec, -1
    s_waitcnt lgkmcnt(4)
    v_cvt_pk_bf16_f32 v28, v16, v17
    v_cvt_pk_bf16_f32 v29, v18, v19
    v_cvt_pk_bf16_f32 v30, v20, v21
    v_cvt_pk_bf16_f32 v31, v22, v23
    v_cvt_pk_bf16_f32 v32, v24, v25
    ds_read_b64 v[16:17], v8 offset:11264
    ds_read_b64 v[18:19], v8 offset:11272
    ds_read_b64 v[20:21], v8 offset:11280
    ds_read_b64 v[22:23], v8 offset:11288
    ds_read_b64 v[24:25], v9 offset:11328
    s_waitcnt lgkmcnt(7)
    v_mfma_f32_32x32x16_bf16 v[60:75], v[28:31], v[44:47], 0
    v_mfma_f32_32x32x16_bf16 v[76:91], v[28:31], v[52:55], 0
    s_waitcnt lgkmcnt(5)
    v_mfma_f32_32x32x16_bf16 v[60:75], v[32:35], v[48:51], v[60:75]
    v_mfma_f32_32x32x16_bf16 v[76:91], v[32:35], v[56:59], v[76:91]
    s_waitcnt lgkmcnt(0)
    v_cvt_pk_bf16_f32 v36, v16, v17
    v_cvt_pk_bf16_f32 v37, v18, v19
    v_cvt_pk_bf16_f32 v38, v20, v21
    v_cvt_pk_bf16_f32 v39, v22, v23
    v_cvt_pk_bf16_f32 v40, v24, v25
    s_nop 4
    v_add_f32 v72, s42, v71
    v_add_f32 v88, s42, v87
    v_rcp_f32 v72, v72
    v_rcp_f32 v88, v88
    v_pk_mul_f32 v[60:61], v[60:61], v[72:73] op_sel_hi:[1,0]
    v_pk_mul_f32 v[62:63], v[62:63], v[72:73] op_sel_hi:[1,0]
    v_pk_mul_f32 v[64:65], v[64:65], v[72:73] op_sel_hi:[1,0]
    v_pk_mul_f32 v[66:67], v[66:67], v[72:73] op_sel_hi:[1,0]
    v_pk_mul_f32 v[68:69], v[68:69], v[72:73] op_sel_hi:[1,0]
    v_cvt_pk_bf16_f32 v100, v60, v61
    v_cvt_pk_bf16_f32 v101, v62, v63
    v_cvt_pk_bf16_f32 v102, v64, v65
    v_cvt_pk_bf16_f32 v103, v66, v67
    v_cvt_pk_bf16_f32 v92, v68, v69
    ds_write_b128 v10, v[100:103] offset:0
    v_pk_mul_f32 v[76:77], v[76:77], v[88:89] op_sel_hi:[1,0]
    v_pk_mul_f32 v[78:79], v[78:79], v[88:89] op_sel_hi:[1,0]
    v_pk_mul_f32 v[80:81], v[80:81], v[88:89] op_sel_hi:[1,0]
    v_pk_mul_f32 v[82:83], v[82:83], v[88:89] op_sel_hi:[1,0]
    v_pk_mul_f32 v[84:85], v[84:85], v[88:89] op_sel_hi:[1,0]
    v_cvt_pk_bf16_f32 v104, v76, v77
    v_cvt_pk_bf16_f32 v105, v78, v79
    v_cvt_pk_bf16_f32 v106, v80, v81
    v_cvt_pk_bf16_f32 v107, v82, v83
    v_cvt_pk_bf16_f32 v96, v84, v85
    ds_write_b128 v6, v[104:107] offset:0
    s_waitcnt lgkmcnt(0)
    s_barrier
    ds_read_b128 v[44:47], v10 offset:9216
    ds_read_b128 v[52:55], v6 offset:9216
    s_mov_b64 exec, s[50:51]
    ds_read_b32 v48, v11 offset:9216
    ds_read_b32 v56, v7 offset:9216
    s_mov_b64 exec, -1
    ds_read_b64 v[16:17], v8 offset:22528
    ds_read_b64 v[18:19], v8 offset:22536
    ds_read_b64 v[20:21], v8 offset:22544
    ds_read_b64 v[22:23], v8 offset:22552
    ds_read_b64 v[24:25], v9 offset:22592
    s_waitcnt lgkmcnt(7)
    v_mfma_f32_32x32x16_bf16 v[60:75], v[36:39], v[44:47], 0
    v_mfma_f32_32x32x16_bf16 v[76:91], v[36:39], v[52:55], 0
    s_waitcnt lgkmcnt(5)
    v_mfma_f32_32x32x16_bf16 v[60:75], v[40:43], v[48:51], v[60:75]
    v_mfma_f32_32x32x16_bf16 v[76:91], v[40:43], v[56:59], v[76:91]
    s_waitcnt lgkmcnt(0)
    v_cvt_pk_bf16_f32 v28, v16, v17
    v_cvt_pk_bf16_f32 v29, v18, v19
    v_cvt_pk_bf16_f32 v30, v20, v21
    v_cvt_pk_bf16_f32 v31, v22, v23
    v_cvt_pk_bf16_f32 v32, v24, v25
    s_nop 4
    v_add_f32 v72, s42, v71
    v_add_f32 v88, s42, v87
    v_rcp_f32 v72, v72
    v_rcp_f32 v88, v88
    v_pk_mul_f32 v[60:61], v[60:61], v[72:73] op_sel_hi:[1,0]
    v_pk_mul_f32 v[62:63], v[62:63], v[72:73] op_sel_hi:[1,0]
    v_pk_mul_f32 v[64:65], v[64:65], v[72:73] op_sel_hi:[1,0]
    v_pk_mul_f32 v[66:67], v[66:67], v[72:73] op_sel_hi:[1,0]
    v_pk_mul_f32 v[68:69], v[68:69], v[72:73] op_sel_hi:[1,0]
    v_cvt_pk_bf16_f32 v100, v60, v61
    v_cvt_pk_bf16_f32 v101, v62, v63
    v_cvt_pk_bf16_f32 v102, v64, v65
    v_cvt_pk_bf16_f32 v103, v66, v67
    v_cvt_pk_bf16_f32 v93, v68, v69
    ds_write_b128 v10, v[100:103] offset:9216
    v_pk_mul_f32 v[76:77], v[76:77], v[88:89] op_sel_hi:[1,0]
    v_pk_mul_f32 v[78:79], v[78:79], v[88:89] op_sel_hi:[1,0]
    v_pk_mul_f32 v[80:81], v[80:81], v[88:89] op_sel_hi:[1,0]
    v_pk_mul_f32 v[82:83], v[82:83], v[88:89] op_sel_hi:[1,0]
    v_pk_mul_f32 v[84:85], v[84:85], v[88:89] op_sel_hi:[1,0]
    v_cvt_pk_bf16_f32 v104, v76, v77
    v_cvt_pk_bf16_f32 v105, v78, v79
    v_cvt_pk_bf16_f32 v106, v80, v81
    v_cvt_pk_bf16_f32 v107, v82, v83
    v_cvt_pk_bf16_f32 v97, v84, v85
    ds_write_b128 v6, v[104:107] offset:9216
    s_waitcnt lgkmcnt(0)
    s_barrier
    ds_read_b128 v[44:47], v10 offset:18432
    ds_read_b128 v[52:55], v6 offset:18432
    s_mov_b64 exec, s[50:51]
    ds_read_b32 v48, v11 offset:18432
    ds_read_b32 v56, v7 offset:18432
    s_mov_b64 exec, -1
    ds_read_b64 v[16:17], v8 offset:33792
    ds_read_b64 v[18:19], v8 offset:33800
    ds_read_b64 v[20:21], v8 offset:33808
    ds_read_b64 v[22:23], v8 offset:33816
    ds_read_b64 v[24:25], v9 offset:33856
    s_waitcnt lgkmcnt(7)
    v_mfma_f32_32x32x16_bf16 v[60:75], v[28:31], v[44:47], 0
    v_mfma_f32_32x32x16_bf16 v[76:91], v[28:31], v[52:55], 0
    s_waitcnt lgkmcnt(5)
    v_mfma_f32_32x32x16_bf16 v[60:75], v[32:35], v[48:51], v[60:75]
    v_mfma_f32_32x32x16_bf16 v[76:91], v[32:35], v[56:59], v[76:91]
    s_waitcnt lgkmcnt(0)
    v_cvt_pk_bf16_f32 v36, v16, v17
    v_cvt_pk_bf16_f32 v37, v18, v19
    v_cvt_pk_bf16_f32 v38, v20, v21
    v_cvt_pk_bf16_f32 v39, v22, v23
    v_cvt_pk_bf16_f32 v40, v24, v25
    s_nop 4
    v_add_f32 v72, s42, v71
    v_add_f32 v88, s42, v87
    v_rcp_f32 v72, v72
    v_rcp_f32 v88, v88
    v_pk_mul_f32 v[60:61], v[60:61], v[72:73] op_sel_hi:[1,0]
    v_pk_mul_f32 v[62:63], v[62:63], v[72:73] op_sel_hi:[1,0]
    v_pk_mul_f32 v[64:65], v[64:65], v[72:73] op_sel_hi:[1,0]
    v_pk_mul_f32 v[66:67], v[66:67], v[72:73] op_sel_hi:[1,0]
    v_pk_mul_f32 v[68:69], v[68:69], v[72:73] op_sel_hi:[1,0]
    v_cvt_pk_bf16_f32 v100, v60, v61
    v_cvt_pk_bf16_f32 v101, v62, v63
    v_cvt_pk_bf16_f32 v102, v64, v65
    v_cvt_pk_bf16_f32 v103, v66, v67
    v_cvt_pk_bf16_f32 v94, v68, v69
    ds_write_b128 v10, v[100:103] offset:18432
    v_pk_mul_f32 v[76:77], v[76:77], v[88:89] op_sel_hi:[1,0]
    v_pk_mul_f32 v[78:79], v[78:79], v[88:89] op_sel_hi:[1,0]
    v_pk_mul_f32 v[80:81], v[80:81], v[88:89] op_sel_hi:[1,0]
    v_pk_mul_f32 v[82:83], v[82:83], v[88:89] op_sel_hi:[1,0]
    v_pk_mul_f32 v[84:85], v[84:85], v[88:89] op_sel_hi:[1,0]
    v_cvt_pk_bf16_f32 v104, v76, v77
    v_cvt_pk_bf16_f32 v105, v78, v79
    v_cvt_pk_bf16_f32 v106, v80, v81
    v_cvt_pk_bf16_f32 v107, v82, v83
    v_cvt_pk_bf16_f32 v98, v84, v85
    ds_write_b128 v6, v[104:107] offset:18432
    s_waitcnt lgkmcnt(0)
    s_barrier
    ds_read_b128 v[44:47], v10 offset:27648
    ds_read_b128 v[52:55], v6 offset:27648
    s_mov_b64 exec, s[50:51]
    ds_read_b32 v48, v11 offset:27648
    ds_read_b32 v56, v7 offset:27648
    s_mov_b64 exec, -1
    s_waitcnt lgkmcnt(2)
    v_mfma_f32_32x32x16_bf16 v[60:75], v[36:39], v[44:47], 0
    v_mfma_f32_32x32x16_bf16 v[76:91], v[36:39], v[52:55], 0
    s_waitcnt lgkmcnt(0)
    v_mfma_f32_32x32x16_bf16 v[60:75], v[40:43], v[48:51], v[60:75]
    v_mfma_f32_32x32x16_bf16 v[76:91], v[40:43], v[56:59], v[76:91]
    s_nop 10
    v_add_f32 v72, s42, v71
    v_add_f32 v88, s42, v87
    v_rcp_f32 v72, v72
    v_rcp_f32 v88, v88
    v_pk_mul_f32 v[60:61], v[60:61], v[72:73] op_sel_hi:[1,0]
    v_pk_mul_f32 v[62:63], v[62:63], v[72:73] op_sel_hi:[1,0]
    v_pk_mul_f32 v[64:65], v[64:65], v[72:73] op_sel_hi:[1,0]
    v_pk_mul_f32 v[66:67], v[66:67], v[72:73] op_sel_hi:[1,0]
    v_pk_mul_f32 v[68:69], v[68:69], v[72:73] op_sel_hi:[1,0]
    v_cvt_pk_bf16_f32 v100, v60, v61
    v_cvt_pk_bf16_f32 v101, v62, v63
    v_cvt_pk_bf16_f32 v102, v64, v65
    v_cvt_pk_bf16_f32 v103, v66, v67
    v_cvt_pk_bf16_f32 v95, v68, v69
    ds_write_b128 v10, v[100:103] offset:27648
    v_pk_mul_f32 v[76:77], v[76:77], v[88:89] op_sel_hi:[1,0]
    v_pk_mul_f32 v[78:79], v[78:79], v[88:89] op_sel_hi:[1,0]
    v_pk_mul_f32 v[80:81], v[80:81], v[88:89] op_sel_hi:[1,0]
    v_pk_mul_f32 v[82:83], v[82:83], v[88:89] op_sel_hi:[1,0]
    v_pk_mul_f32 v[84:85], v[84:85], v[88:89] op_sel_hi:[1,0]
    v_cvt_pk_bf16_f32 v104, v76, v77
    v_cvt_pk_bf16_f32 v105, v78, v79
    v_cvt_pk_bf16_f32 v106, v80, v81
    v_cvt_pk_bf16_f32 v107, v82, v83
    v_cvt_pk_bf16_f32 v99, v84, v85
    ds_write_b128 v6, v[104:107] offset:27648
    s_mov_b32 exec_hi, 0
    ds_write_b128 v12, v[92:95] offset:1024
    ds_write_b128 v12, v[96:99] offset:37888
    s_mov_b32 exec_hi, -1
    s_waitcnt lgkmcnt(0)
    s_barrier
    s_endpgm
L_L_outA_loader:
    s_lshl_b32 s52, s35, 10
    s_mul_i32 s33, s30, 82944
    s_add_u32 s33, s33, s52
    s_mov_b32 s53, s52
    s_and_b32 s36, s35, 1
    s_lshr_b32 s37, s35, 1
    s_lshl_b32 s37, s37, 10
    s_mul_i32 s41, s36, 36864
    s_add_u32 s41, s41, s37
    s_mul_i32 s40, s31, 73728
    s_add_u32 s40, s40, s41
    s_add_u32 s41, s41, 82944
    s_cmp_lt_u32 s35, 2
    s_cselect_b32 s34, 0, 0x40000000
    v_add_u32 v8, s34, v15
    s_cmp_eq_u32 s35, 0
    s_cselect_b32 s34, 0, 0x40000000
    v_add_u32 v7, s34, v15
    s_waitcnt lgkmcnt(0)
    s_add_u32 s16, s4, s59
    s_addc_u32 s17, s5, 0
    s_mov_b32 s18, 0x240000
    s_mov_b32 s19, 0x00020000
    s_add_u32 s44, s4, s62
    s_addc_u32 s45, s5, 0
    s_mov_b32 s46, 0x13000
    s_mov_b32 s47, 0x00020000
    s_add_u32 s12, s4, 0x1840000
    s_addc_u32 s13, s5, 0
    s_mov_b32 s14, 0xa2000
    s_mov_b32 s15, 0x00020000
    s_add_u32 m0, s52, 36864
    s_add_u32 s34, s52, 0
    buffer_load_dwordx4 v15, s[44:47], s34 offen lds
    s_add_u32 m0, s52, 40960
    s_add_u32 s34, s52, 4096
    buffer_load_dwordx4 v15, s[44:47], s34 offen lds
    s_add_u32 m0, s52, 45056
    s_add_u32 s34, s52, 8192
    buffer_load_dwordx4 v15, s[44:47], s34 offen lds
    s_add_u32 m0, s52, 49152
    s_add_u32 s34, s52, 12288
    buffer_load_dwordx4 v15, s[44:47], s34 offen lds
    s_add_u32 m0, s52, 53248
    s_add_u32 s34, s52, 16384
    buffer_load_dwordx4 v15, s[44:47], s34 offen lds
    s_add_u32 m0, s52, 57344
    s_add_u32 s34, s52, 20480
    buffer_load_dwordx4 v15, s[44:47], s34 offen lds
    s_mov_b32 m0, s41
    s_add_u32 s41, s41, 2048
    buffer_load_dwordx4 v15, s[16:19], s40 offen lds
    s_add_u32 s40, s40, 2048
    s_mov_b32 m0, s41
    s_add_u32 s41, s41, 2048
    buffer_load_dwordx4 v15, s[16:19], s40 offen lds
    s_add_u32 s40, s40, 2048
    s_mov_b32 m0, s41
    s_add_u32 s41, s41, 2048
    buffer_load_dwordx4 v15, s[16:19], s40 offen lds
    s_add_u32 s40, s40, 2048
    s_mov_b32 m0, s41
    s_add_u32 s41, s41, 2048
    buffer_load_dwordx4 v15, s[16:19], s40 offen lds
    s_add_u32 s40, s40, 2048
    s_mov_b32 m0, s41
    s_add_u32 s41, s41, 2048
    buffer_load_dwordx4 v15, s[16:19], s40 offen lds
    s_add_u32 s40, s40, 2048
    s_add_u32 m0, s52, 61440
    s_add_u32 s34, s52, 24576
    buffer_load_dwordx4 v15, s[44:47], s34 offen lds
    s_add_u32 m0, s52, 65536
    s_add_u32 s34, s52, 28672
    buffer_load_dwordx4 v15, s[44:47], s34 offen lds
    s_add_u32 m0, s52, 69632
    s_add_u32 s34, s52, 32768
    buffer_load_dwordx4 v15, s[44:47], s34 offen lds
    s_mov_b32 m0, s41
    s_add_u32 s41, s41, 2048
    buffer_load_dwordx4 v15, s[16:19], s40 offen lds
    s_add_u32 s40, s40, 2048
    s_mov_b32 m0, s41
    s_add_u32 s41, s41, 2048
    buffer_load_dwordx4 v15, s[16:19], s40 offen lds
    s_add_u32 s40, s40, 2048
    s_mov_b32 m0, s41
    s_add_u32 s41, s41, 2048
    buffer_load_dwordx4 v15, s[16:19], s40 offen lds
    s_add_u32 s40, s40, 2048
    s_mov_b32 m0, s41
    s_add_u32 s41, s41, 2048
    buffer_load_dwordx4 v15, s[16:19], s40 offen lds
    s_add_u32 s40, s40, 2048
    s_mov_b32 m0, s53
    s_add_u32 s53, s53, 4096
    buffer_load_dwordx4 v15, s[12:15], s33 offen lds
    s_add_u32 s33, s33, 4096
    s_mov_b32 m0, s53
    s_add_u32 s53, s53, 4096
    buffer_load_dwordx4 v15, s[12:15], s33 offen lds
    s_add_u32 s33, s33, 4096
    s_mov_b32 m0, s53
    s_add_u32 s53, s53, 4096
    buffer_load_dwordx4 v15, s[12:15], s33 offen lds
    s_add_u32 s33, s33, 4096
    s_mov_b32 m0, s53
    s_add_u32 s53, s53, 4096
    buffer_load_dwordx4 v15, s[12:15], s33 offen lds
    s_add_u32 s33, s33, 4096
    s_mov_b32 m0, s53
    s_add_u32 s53, s53, 4096
    buffer_load_dwordx4 v15, s[12:15], s33 offen lds
    s_add_u32 s33, s33, 4096
    s_waitcnt vmcnt(12)
    s_barrier
    s_add_u32 m0, s52, 73728
    s_add_u32 s34, s52, 36864
    buffer_load_dwordx4 v15, s[44:47], s34 offen lds
    s_add_u32 m0, s52, 77824
    s_add_u32 s34, s52, 40960
    buffer_load_dwordx4 v15, s[44:47], s34 offen lds
    s_mov_b32 m0, s41
    s_add_u32 s41, s41, 2048
    buffer_load_dwordx4 v15, s[16:19], s40 offen lds
    s_add_u32 s40, s40, 2048
    s_mov_b32 m0, s41
    s_add_u32 s41, s41, 2048
    buffer_load_dwordx4 v15, s[16:19], s40 offen lds
    s_add_u32 s40, s40, 2048
    s_mov_b32 m0, s41
    s_add_u32 s41, s41, 2048
    buffer_load_dwordx4 v15, s[16:19], s40 offen lds
    s_add_u32 s40, s40, 2048
    s_mov_b32 m0, s41
    s_add_u32 s41, s41, 2048
    buffer_load_dwordx4 v15, s[16:19], s40 offen lds
    s_add_u32 s40, s40, 2048
    s_mov_b32 m0, s41
    s_add_u32 s41, s41, 2048
    buffer_load_dwordx4 v15, s[16:19], s40 offen lds
    s_add_u32 s40, s40, 2048
    s_mov_b32 m0, s53
    s_add_u32 s53, s53, 4096
    buffer_load_dwordx4 v15, s[12:15], s33 offen lds
    s_add_u32 s33, s33, 4096
    s_mov_b32 m0, s53
    s_add_u32 s53, s53, 4096
    buffer_load_dwordx4 v15, s[12:15], s33 offen lds
    s_add_u32 s33, s33, 4096
    s_mov_b32 m0, s53
    s_add_u32 s53, s53, 4096
    buffer_load_dwordx4 v15, s[12:15], s33 offen lds
    s_add_u32 s33, s33, 4096
    s_mov_b32 m0, s53
    s_add_u32 s53, s53, 4096
    buffer_load_dwordx4 v15, s[12:15], s33 offen lds
    s_add_u32 s33, s33, 4096
    s_waitcnt vmcnt(11)
    s_barrier
    s_mov_b32 m0, s41
    s_add_u32 s41, s41, 2048
    buffer_load_dwordx4 v15, s[16:19], s40 offen lds
    s_add_u32 s40, s40, 2048
    s_mov_b32 m0, s41
    s_add_u32 s41, s41, 2048
    buffer_load_dwordx4 v15, s[16:19], s40 offen lds
    s_add_u32 s40, s40, 2048
    s_mov_b32 m0, s41
    s_add_u32 s41, s41, 2048
    buffer_load_dwordx4 v15, s[16:19], s40 offen lds
    s_add_u32 s40, s40, 2048
    s_mov_b32 m0, s41
    s_add_u32 s41, s41, 2048
    buffer_load_dwordx4 v15, s[16:19], s40 offen lds
    s_add_u32 s40, s40, 2048
    s_mov_b32 m0, s53
    s_add_u32 s53, s53, 4096
    buffer_load_dwordx4 v15, s[12:15], s33 offen lds
    s_add_u32 s33, s33, 4096
    s_mov_b32 m0, s53
    s_add_u32 s53, s53, 4096
    buffer_load_dwordx4 v15, s[12:15], s33 offen lds
    s_add_u32 s33, s33, 4096
    s_mov_b32 m0, s53
    s_add_u32 s53, s53, 4096
    buffer_load_dwordx4 v15, s[12:15], s33 offen lds
    s_add_u32 s33, s33, 4096
    s_mov_b32 m0, s53
    s_add_u32 s53, s53, 4096
    buffer_load_dwordx4 v15, s[12:15], s33 offen lds
    s_add_u32 s33, s33, 4096
    s_mov_b32 m0, s53
    s_add_u32 s53, s53, 4096
    buffer_load_dwordx4 v15, s[12:15], s33 offen lds
    s_add_u32 s33, s33, 4096
    s_waitcnt vmcnt(9)
    s_barrier
    s_mov_b32 m0, s53
    s_add_u32 s53, s53, 4096
    buffer_load_dwordx4 v15, s[12:15], s33 offen lds
    s_add_u32 s33, s33, 4096
    s_mov_b32 m0, s53
    s_add_u32 s53, s53, 4096
    buffer_load_dwordx4 v15, s[12:15], s33 offen lds
    s_add_u32 s33, s33, 4096
    s_mov_b32 m0, s53
    s_add_u32 s53, s53, 4096
    buffer_load_dwordx4 v15, s[12:15], s33 offen lds
    s_add_u32 s33, s33, 4096
    s_waitcnt vmcnt(3)
    s_barrier
    s_mov_b32 m0, s53
    s_add_u32 s53, s53, 4096
    buffer_load_dwordx4 v15, s[12:15], s33 offen lds
    s_add_u32 s33, s33, 4096
    s_mov_b32 m0, s53
    s_add_u32 s53, s53, 4096
    buffer_load_dwordx4 v15, s[12:15], s33 offen lds
    s_add_u32 s33, s33, 4096
    s_mov_b32 m0, s53
    s_add_u32 s53, s53, 4096
    buffer_load_dwordx4 v15, s[12:15], s33 offen lds
    s_add_u32 s33, s33, 4096
    s_cmp_eq_u32 s35, 0
    s_cselect_b32 m0, s53, 156672
    s_nop 0
    buffer_load_dwordx4 v7, s[12:15], s33 offen lds
    s_waitcnt vmcnt(3)
    s_barrier
    s_waitcnt vmcnt(0)
    s_barrier
L_L_outA_end:
    s_endpgm
.globl attn_kernel
.p2align 8
.type attn_kernel,@function
attn_kernel:
    s_mov_b32 s56, 0
    s_cmp_ge_u32 s2, 256
    s_cbranch_scc1 L_attn_kernel_end
    s_load_dwordx2 s[4:5], s[0:1], 64
    s_and_b32 s30, s2, 7
    s_lshr_b32 s31, s2, 3
    s_and_b32 s32, s31, 3
    s_lshl_b32 s30, s30, 2
    s_add_u32 s30, s30, s32
    s_lshr_b32 s31, s31, 2
    v_lshrrev_b32 v4, 6, v0
    v_and_b32 v3, 63, v0
    v_readfirstlane_b32 s35, v4
    s_mul_i32 s33, s30, 155648
    s_lshr_b32 s40, s35, 3
    s_and_b32 s41, s35, 7
    s_mul_i32 s42, s40, 77824
    v_lshlrev_b32 v1, 4, v3
    s_lshl_b32 s36, s31, 3
    s_add_u32 s36, s36, s41
    s_mul_i32 s37, s36, 1152
    s_mul_i32 s38, s30, 73728
    s_add_u32 s37, s37, s38
    s_add_u32 s37, s37, 0xb40000
    s_add_u32 s37, s37, s56
    s_add_u32 s33, s33, s56
    v_and_b32 v5, 31, v3
    v_lshrrev_b32 v6, 5, v3
    v_lshlrev_b32 v7, 2, v5
    v_lshl_add_u32 v2, v6, 30, v7
    s_lshl_b32 s39, s41, 10
    s_add_u32 s39, s39, s42
    s_add_u32 s43, s42, 76800
    s_waitcnt lgkmcnt(0)
    s_add_u32 s8, s4, s33
    s_addc_u32 s9, s5, 0
    s_add_u32 s8, s8, 0xf40000
    s_addc_u32 s9, s9, 0
    s_mov_b32 s10, 155648
    s_mov_b32 s11, 0x00020000
    s_mov_b32 s16, s4
    s_mov_b32 s17, s5
    s_mov_b32 s18, 0x8000000
    s_mov_b32 s19, 0x00020000
    buffer_load_dwordx4 v[88:91], v1, s[16:19], s37 offen
    buffer_load_dword v92, v2, s[16:19], s37 offen offset:1024
    s_mov_b32 m0, s39
    s_nop 0
    buffer_load_dwordx4 v1, s[8:11], s39 offen lds
    s_add_u32 s39, s39, 8192
    s_mov_b32 m0, s39
    s_nop 0
    buffer_load_dwordx4 v1, s[8:11], s39 offen lds
    s_add_u32 s39, s39, 8192
    v_add_u32 v115, s42, v1
    v_add_u32 v8, 1024, v7
    v_add_u32 v116, s42, v8
    v_or_b32 v9, 4, v5
    v_cmp_eq_u32 vcc, 23, v9
    v_cmp_gt_u32 s[52:53], 18, v5
    s_nop 0
    v_cndmask_b32_e64 v8, 19, 18, vcc
    v_cndmask_b32 v8, v8, v5, s[52:53]
    s_mov_b64 s[54:55], s[52:53]
    v_lshlrev_b32 v8, 4, v8
    v_mul_u32_u24 v9, 320, v6
    v_add3_u32 v8, v8, v9, s42
    v_add_u32 v117, 1152, v8
    v_mov_b32 v93, 0
    v_mov_b32 v101, 0
    v_mov_b32 v94, 0
    v_mov_b32 v102, 0
    v_mov_b32 v95, 0
    v_mov_b32 v103, 0
    s_mov_b32 s50, 0
    v_mov_b32 v10, 0
L_attn_kernel_run:
    v_mov_b32 v11, v10
    s_nop 1
    v_permlane32_swap_b32 v11, v10
    s_nop 1
    v_max_f32 v10, v10, v11
    v_sub_f32 v10, 0, v10
    v_cvt_pk_bf16_f32 v11, v10, v10
    v_cmp_eq_u32 vcc, 0, v6
    v_and_b32 v11, 0xffff0000, v11
    v_sub_f32 v12, v10, v11
    v_cvt_pk_bf16_f32 v10, v10, v12
    v_mov_b32 v101, 0x3f803f80
    v_and_b32 v12, 0xffff0000, v10
    v_add_f32 v72, v11, v12
    v_cndmask_b32 v93, 0, v10, vcc
    v_mov_b32 v56, 0
    v_mov_b32 v57, 0
    v_mov_b32 v58, 0
    v_mov_b32 v59, 0
    v_mov_b32 v60, 0
    v_mov_b32 v61, 0
    v_mov_b32 v62, 0
    v_mov_b32 v63, 0
    v_mov_b32 v64, 0
    v_mov_b32 v65, 0
    v_mov_b32 v66, 0
    v_mov_b32 v67, 0
    v_mov_b32 v68, 0
    v_mov_b32 v69, 0
    v_mov_b32 v70, 0
    v_mov_b32 v71, 0
    v_mov_b32 v112, v115
    v_mov_b32 v113, v116
    v_mov_b32 v114, v117
    s_cmp_lg_u32 s50, 0
    s_cbranch_scc1 L_attn_kernel_s01
    s_waitcnt vmcnt(0)
    s_barrier
L_attn_kernel_s01:
    ds_read_b128 v[96:99], v112
    ds_read_b32 v100, v113
    s_waitcnt lgkmcnt(0)
    v_mfma_f32_32x32x16_bf16 v[16:31], v[96:99], v[88:91], 0
    v_mfma_f32_32x32x16_bf16 v[16:31], v[100:103], v[92:95], v[16:31]
    ds_read_b128 v[96:99], v112 offset:2432
    ds_read_b32 v100, v113 offset:2432
    ds_read_b128 v[104:107], v114
    s_nop 8
    s_cmp_lg_u32 s50, 0
    s_cbranch_scc1 L_attn_kernel_sd2
    s_mov_b32 m0, s39
    s_nop 0
    buffer_load_dwordx4 v1, s[8:11], s39 offen lds
    s_add_u32 s39, s39, 8192
L_attn_kernel_sd2:
    s_setprio 3
    v_exp_f32 v16, v16
    ds_read_b128 v[108:111], v114 offset:640
    v_exp_f32 v17, v17
    v_exp_f32 v18, v18
    v_exp_f32 v19, v19
    v_cvt_pk_bf16_f32 v48, v16, v17
    s_waitcnt lgkmcnt(3)
    v_mfma_f32_32x32x16_bf16 v[32:47], v[96:99], v[88:91], 0
    ds_read_b128 v[96:99], v112 offset:4864
    v_exp_f32 v20, v20
    v_exp_f32 v21, v21
    v_cvt_pk_bf16_f32 v49, v18, v19
    v_exp_f32 v22, v22
    v_exp_f32 v23, v23
    v_cvt_pk_bf16_f32 v50, v20, v21
    s_waitcnt lgkmcnt(3)
    v_mfma_f32_32x32x8bf16_1k v[32:47], v[100:101], v[92:93], v[32:47]
    ds_read_b32 v100, v113 offset:4864
    v_exp_f32 v24, v24
    v_exp_f32 v25, v25
    v_cvt_pk_bf16_f32 v51, v22, v23
    v_exp_f32 v26, v26
    v_exp_f32 v27, v27
    v_cvt_pk_bf16_f32 v52, v24, v25
    s_waitcnt lgkmcnt(3)
    v_mfma_f32_32x32x16_bf16 v[56:71], v[104:107], v[48:51], v[56:71]
    ds_read_b128 v[104:107], v114 offset:2432
    v_exp_f32 v28, v28
    v_exp_f32 v29, v29
    v_cvt_pk_bf16_f32 v53, v26, v27
    v_exp_f32 v30, v30
    v_exp_f32 v31, v31
    v_cvt_pk_bf16_f32 v54, v28, v29
    v_cvt_pk_bf16_f32 v55, v30, v31
    s_cmp_lg_u32 s50, 0
    s_cbranch_scc1 L_attn_kernel_sd3
    s_mov_b32 m0, s39
    s_nop 0
    buffer_load_dwordx4 v1, s[8:11], s39 offen lds
    s_add_u32 s39, s39, 8192
L_attn_kernel_sd3:
    v_exp_f32 v32, v32
    s_waitcnt lgkmcnt(3)
    v_mfma_f32_32x32x16_bf16 v[56:71], v[108:111], v[52:55], v[56:71]
    ds_read_b128 v[108:111], v114 offset:3072
    v_exp_f32 v33, v33
    v_exp_f32 v34, v34
    v_exp_f32 v35, v35
    v_cvt_pk_bf16_f32 v48, v32, v33
    s_waitcnt lgkmcnt(3)
    v_mfma_f32_32x32x16_bf16 v[16:31], v[96:99], v[88:91], 0
    ds_read_b128 v[96:99], v112 offset:7296
    v_exp_f32 v36, v36
    v_exp_f32 v37, v37
    v_cvt_pk_bf16_f32 v49, v34, v35
    v_exp_f32 v38, v38
    v_exp_f32 v39, v39
    v_cvt_pk_bf16_f32 v50, v36, v37
    s_waitcnt lgkmcnt(3)
    v_mfma_f32_32x32x8bf16_1k v[16:31], v[100:101], v[92:93], v[16:31]
    ds_read_b32 v100, v113 offset:7296
    v_exp_f32 v40, v40
    v_exp_f32 v41, v41
    v_cvt_pk_bf16_f32 v51, v38, v39
    v_exp_f32 v42, v42
    v_exp_f32 v43, v43
    v_cvt_pk_bf16_f32 v52, v40, v41
    s_waitcnt lgkmcnt(3)
    v_mfma_f32_32x32x16_bf16 v[56:71], v[104:107], v[48:51], v[56:71]
    ds_read_b128 v[104:107], v114 offset:4864
    v_exp_f32 v44, v44
    v_exp_f32 v45, v45
    v_cvt_pk_bf16_f32 v53, v42, v43
    v_exp_f32 v46, v46
    v_exp_f32 v47, v47
    v_cvt_pk_bf16_f32 v54, v44, v45
    v_cvt_pk_bf16_f32 v55, v46, v47
    s_cmp_lg_u32 s50, 0
    s_cbranch_scc1 L_attn_kernel_sk4
    s_waitcnt vmcnt(1)
    s_barrier
L_attn_kernel_sk4:
    s_cmp_lg_u32 s50, 0
    s_cbranch_scc1 L_attn_kernel_sd5
    s_mov_b32 m0, s39
    s_nop 0
    buffer_load_dwordx4 v1, s[8:11], s39 offen lds
    s_add_u32 s39, s39, 8192
L_attn_kernel_sd5:
    v_exp_f32 v16, v16
    s_waitcnt lgkmcnt(3)
    v_mfma_f32_32x32x16_bf16 v[56:71], v[108:111], v[52:55], v[56:71]
    ds_read_b128 v[108:111], v114 offset:5504
    v_exp_f32 v17, v17
    v_exp_f32 v18, v18
    v_exp_f32 v19, v19
    v_cvt_pk_bf16_f32 v48, v16, v17
    s_waitcnt lgkmcnt(3)
    v_mfma_f32_32x32x16_bf16 v[32:47], v[96:99], v[88:91], 0
    ds_read_b128 v[96:99], v112 offset:9728
    v_exp_f32 v20, v20
    v_exp_f32 v21, v21
    v_cvt_pk_bf16_f32 v49, v18, v19
    v_exp_f32 v22, v22
    v_exp_f32 v23, v23
    v_cvt_pk_bf16_f32 v50, v20, v21
    s_waitcnt lgkmcnt(3)
    v_mfma_f32_32x32x8bf16_1k v[32:47], v[100:101], v[92:93], v[32:47]
    ds_read_b32 v100, v113 offset:9728
    v_exp_f32 v24, v24
    v_exp_f32 v25, v25
    v_cvt_pk_bf16_f32 v51, v22, v23
    v_exp_f32 v26, v26
    v_exp_f32 v27, v27
    v_cvt_pk_bf16_f32 v52, v24, v25
    s_waitcnt lgkmcnt(3)
    v_mfma_f32_32x32x16_bf16 v[56:71], v[104:107], v[48:51], v[56:71]
    ds_read_b128 v[104:107], v114 offset:7296
    v_exp_f32 v28, v28
    v_exp_f32 v29, v29
    v_cvt_pk_bf16_f32 v53, v26, v27
    v_exp_f32 v30, v30
    v_exp_f32 v31, v31
    v_cvt_pk_bf16_f32 v54, v28, v29
    v_cvt_pk_bf16_f32 v55, v30, v31
    s_cmp_lg_u32 s50, 0
    s_cbranch_scc1 L_attn_kernel_sd6
    s_mov_b32 m0, s39
    s_nop 0
    buffer_load_dwordx4 v1, s[8:11], s39 offen lds
    s_add_u32 s39, s39, 8192
L_attn_kernel_sd6:
    v_exp_f32 v32, v32
    s_waitcnt lgkmcnt(3)
    v_mfma_f32_32x32x16_bf16 v[56:71], v[108:111], v[52:55], v[56:71]
    ds_read_b128 v[108:111], v114 offset:7936
    v_exp_f32 v33, v33
    v_exp_f32 v34, v34
    v_exp_f32 v35, v35
    v_cvt_pk_bf16_f32 v48, v32, v33
    s_waitcnt lgkmcnt(3)
    v_mfma_f32_32x32x16_bf16 v[16:31], v[96:99], v[88:91], 0
    ds_read_b128 v[96:99], v112 offset:12160
    v_exp_f32 v36, v36
    v_exp_f32 v37, v37
    v_cvt_pk_bf16_f32 v49, v34, v35
    v_exp_f32 v38, v38
    v_exp_f32 v39, v39
    v_cvt_pk_bf16_f32 v50, v36, v37
    s_waitcnt lgkmcnt(3)
    v_mfma_f32_32x32x8bf16_1k v[16:31], v[100:101], v[92:93], v[16:31]
    ds_read_b32 v100, v113 offset:12160
    v_exp_f32 v40, v40
    v_exp_f32 v41, v41
    v_cvt_pk_bf16_f32 v51, v38, v39
    v_exp_f32 v42, v42
    v_exp_f32 v43, v43
    v_cvt_pk_bf16_f32 v52, v40, v41
    s_waitcnt lgkmcnt(3)
    v_mfma_f32_32x32x16_bf16 v[56:71], v[104:107], v[48:51], v[56:71]
    ds_read_b128 v[104:107], v114 offset:9728
    v_exp_f32 v44, v44
    v_exp_f32 v45, v45
    v_cvt_pk_bf16_f32 v53, v42, v43
    v_exp_f32 v46, v46
    v_exp_f32 v47, v47
    v_cvt_pk_bf16_f32 v54, v44, v45
    v_cvt_pk_bf16_f32 v55, v46, v47
    s_cmp_lg_u32 s50, 0
    s_cbranch_scc1 L_attn_kernel_sd7
    s_mov_b32 m0, s39
    s_nop 0
    buffer_load_dwordx4 v1, s[8:11], s39 offen lds
    s_add_u32 s39, s39, 8192
L_attn_kernel_sd7:
    v_exp_f32 v16, v16
    s_waitcnt lgkmcnt(3)
    v_mfma_f32_32x32x16_bf16 v[56:71], v[108:111], v[52:55], v[56:71]
    ds_read_b128 v[108:111], v114 offset:10368
    v_exp_f32 v17, v17
    v_exp_f32 v18, v18
    v_exp_f32 v19, v19
    v_cvt_pk_bf16_f32 v48, v16, v17
    s_waitcnt lgkmcnt(3)
    v_mfma_f32_32x32x16_bf16 v[32:47], v[96:99], v[88:91], 0
    ds_read_b128 v[96:99], v112 offset:14592
    v_exp_f32 v20, v20
    v_exp_f32 v21, v21
    v_cvt_pk_bf16_f32 v49, v18, v19
    v_exp_f32 v22, v22
    v_exp_f32 v23, v23
    v_cvt_pk_bf16_f32 v50, v20, v21
    s_waitcnt lgkmcnt(3)
    v_mfma_f32_32x32x8bf16_1k v[32:47], v[100:101], v[92:93], v[32:47]
    ds_read_b32 v100, v113 offset:14592
    v_exp_f32 v24, v24
    v_exp_f32 v25, v25
    v_cvt_pk_bf16_f32 v51, v22, v23
    v_exp_f32 v26, v26
    v_exp_f32 v27, v27
    v_cvt_pk_bf16_f32 v52, v24, v25
    s_waitcnt lgkmcnt(3)
    v_mfma_f32_32x32x16_bf16 v[56:71], v[104:107], v[48:51], v[56:71]
    ds_read_b128 v[104:107], v114 offset:12160
    v_exp_f32 v28, v28
    v_exp_f32 v29, v29
    v_cvt_pk_bf16_f32 v53, v26, v27
    v_exp_f32 v30, v30
    v_exp_f32 v31, v31
    v_cvt_pk_bf16_f32 v54, v28, v29
    v_cvt_pk_bf16_f32 v55, v30, v31
    s_cmp_lg_u32 s50, 0
    s_cbranch_scc1 L_attn_kernel_sd8
    s_mov_b32 m0, s39
    s_nop 0
    buffer_load_dwordx4 v1, s[8:11], s39 offen lds
    s_add_u32 s39, s39, 8192
L_attn_kernel_sd8:
    v_exp_f32 v32, v32
    s_waitcnt lgkmcnt(3)
    v_mfma_f32_32x32x16_bf16 v[56:71], v[108:111], v[52:55], v[56:71]
    ds_read_b128 v[108:111], v114 offset:12800
    v_exp_f32 v33, v33
    v_exp_f32 v34, v34
    v_exp_f32 v35, v35
    v_cvt_pk_bf16_f32 v48, v32, v33
    s_waitcnt lgkmcnt(3)
    v_mfma_f32_32x32x16_bf16 v[16:31], v[96:99], v[88:91], 0
    ds_read_b128 v[96:99], v112 offset:17024
    v_exp_f32 v36, v36
    v_exp_f32 v37, v37
    v_cvt_pk_bf16_f32 v49, v34, v35
    v_exp_f32 v38, v38
    v_exp_f32 v39, v39
    v_cvt_pk_bf16_f32 v50, v36, v37
    s_waitcnt lgkmcnt(3)
    v_mfma_f32_32x32x8bf16_1k v[16:31], v[100:101], v[92:93], v[16:31]
    ds_read_b32 v100, v113 offset:17024
    v_exp_f32 v40, v40
    v_exp_f32 v41, v41
    v_cvt_pk_bf16_f32 v51, v38, v39
    v_exp_f32 v42, v42
    v_exp_f32 v43, v43
    v_cvt_pk_bf16_f32 v52, v40, v41
    s_waitcnt lgkmcnt(3)
    v_mfma_f32_32x32x16_bf16 v[56:71], v[104:107], v[48:51], v[56:71]
    ds_read_b128 v[104:107], v114 offset:14592
    v_exp_f32 v44, v44
    v_exp_f32 v45, v45
    v_cvt_pk_bf16_f32 v53, v42, v43
    v_exp_f32 v46, v46
    v_exp_f32 v47, v47
    v_cvt_pk_bf16_f32 v54, v44, v45
    v_cvt_pk_bf16_f32 v55, v46, v47
    s_cmp_lg_u32 s50, 0
    s_cbranch_scc1 L_attn_kernel_sd9
    s_mov_b32 m0, s39
    s_nop 0
    buffer_load_dwordx4 v1, s[8:11], s39 offen lds
    s_add_u32 s39, s39, 8192
L_attn_kernel_sd9:
    v_exp_f32 v16, v16
    s_waitcnt lgkmcnt(3)
    v_mfma_f32_32x32x16_bf16 v[56:71], v[108:111], v[52:55], v[56:71]
    ds_read_b128 v[108:111], v114 offset:15232
    v_exp_f32 v17, v17
    v_exp_f32 v18, v18
    v_exp_f32 v19, v19
    v_cvt_pk_bf16_f32 v48, v16, v17
    s_waitcnt lgkmcnt(3)
    v_mfma_f32_32x32x16_bf16 v[32:47], v[96:99], v[88:91], 0
    ds_read_b128 v[96:99], v112 offset:19456
    v_exp_f32 v20, v20
    v_exp_f32 v21, v21
    v_cvt_pk_bf16_f32 v49, v18, v19
    v_exp_f32 v22, v22
    v_exp_f32 v23, v23
    v_cvt_pk_bf16_f32 v50, v20, v21
    s_waitcnt lgkmcnt(3)
    v_mfma_f32_32x32x8bf16_1k v[32:47], v[100:101], v[92:93], v[32:47]
    ds_read_b32 v100, v113 offset:19456
    v_exp_f32 v24, v24
    v_exp_f32 v25, v25
    v_cvt_pk_bf16_f32 v51, v22, v23
    v_exp_f32 v26, v26
    v_exp_f32 v27, v27
    v_cvt_pk_bf16_f32 v52, v24, v25
    s_waitcnt lgkmcnt(3)
    v_mfma_f32_32x32x16_bf16 v[56:71], v[104:107], v[48:51], v[56:71]
    ds_read_b128 v[104:107], v114 offset:17024
    v_exp_f32 v28, v28
    v_exp_f32 v29, v29
    v_cvt_pk_bf16_f32 v53, v26, v27
    v_exp_f32 v30, v30
    v_exp_f32 v31, v31
    v_cvt_pk_bf16_f32 v54, v28, v29
    v_cvt_pk_bf16_f32 v55, v30, v31
    s_cmp_lg_u32 s50, 0
    s_cbranch_scc1 L_attn_kernel_sd10
    s_min_u32 s39, s39, s43
    s_mov_b32 m0, s39
    s_nop 0
    buffer_load_dwordx4 v1, s[8:11], s39 offen lds
    s_add_u32 s39, s39, 8192
L_attn_kernel_sd10:
    v_exp_f32 v32, v32
    s_waitcnt lgkmcnt(3)
    v_mfma_f32_32x32x16_bf16 v[56:71], v[108:111], v[52:55], v[56:71]
    ds_read_b128 v[108:111], v114 offset:17664
    v_exp_f32 v33, v33
    v_exp_f32 v34, v34
    v_exp_f32 v35, v35
    v_cvt_pk_bf16_f32 v48, v32, v33
    s_waitcnt lgkmcnt(3)
    v_mfma_f32_32x32x16_bf16 v[16:31], v[96:99], v[88:91], 0
    ds_read_b128 v[96:99], v112 offset:21888
    v_exp_f32 v36, v36
    v_exp_f32 v37, v37
    v_cvt_pk_bf16_f32 v49, v34, v35
    v_exp_f32 v38, v38
    v_exp_f32 v39, v39
    v_cvt_pk_bf16_f32 v50, v36, v37
    s_waitcnt lgkmcnt(3)
    v_mfma_f32_32x32x8bf16_1k v[16:31], v[100:101], v[92:93], v[16:31]
    ds_read_b32 v100, v113 offset:21888
    v_exp_f32 v40, v40
    v_exp_f32 v41, v41
    v_cvt_pk_bf16_f32 v51, v38, v39
    v_exp_f32 v42, v42
    v_exp_f32 v43, v43
    v_cvt_pk_bf16_f32 v52, v40, v41
    s_waitcnt lgkmcnt(3)
    v_mfma_f32_32x32x16_bf16 v[56:71], v[104:107], v[48:51], v[56:71]
    ds_read_b128 v[104:107], v114 offset:19456
    v_exp_f32 v44, v44
    v_exp_f32 v45, v45
    v_cvt_pk_bf16_f32 v53, v42, v43
    v_exp_f32 v46, v46
    v_exp_f32 v47, v47
    v_cvt_pk_bf16_f32 v54, v44, v45
    v_cvt_pk_bf16_f32 v55, v46, v47
    s_cmp_lg_u32 s50, 0
    s_cbranch_scc1 L_attn_kernel_sk11
    s_waitcnt vmcnt(0)
    s_barrier
    s_and_b32 s28, s2, 7
    s_lshr_b32 s29, s2, 3
    v_mov_b32 v118, 0x40000000
    s_mul_i32 s34, s29, 20736
    s_add_u32 s34, s34, 0x1831f00
    v_lshl_add_u32 v119, v0, 7, s34
    v_cmp_gt_u32 vcc, 612, v0
    s_nop 1
    v_cndmask_b32 v118, v118, v119, vcc
    s_mul_i32 s34, s29, 36864
    s_add_u32 s34, s34, 0x1ffaf00
    s_bitcmp1_b32 s28, 0
    s_cselect_b32 s55, 1179648, 0
    s_add_u32 s34, s34, s55
    v_lshl_add_u32 v119, v0, 7, s34
    v_cmp_gt_u32 vcc, 450, v0
    s_nop 1
    v_cndmask_b32 v118, v118, v119, vcc
    s_mul_i32 s34, s29, 20736
    s_add_u32 s34, s34, 0x1900000
    v_lshl_add_u32 v119, v0, 7, s34
    v_cmp_gt_u32 vcc, 162, v0
    s_nop 1
    v_cndmask_b32 v118, v118, v119, vcc
    buffer_load_dword v119, v118, s[16:19], 0 offen
    s_getpc_b64 s[20:21]
L_attn_kernel_pc12:
    s_sub_u32 s20, s20, L_attn_kernel_pc12-L_text_start
    s_subb_u32 s21, s21, 0
    s_mov_b32 s22, L_text_end-L_text_start
    s_mov_b32 s23, 0x00020000
    s_cmp_lt_u32 s2, 16
    s_cselect_b32 s34, 0, 0x40000000
    v_lshl_add_u32 v2, v0, 7, s34
    buffer_load_dword v119, v2, s[20:23], 0 offen
L_attn_kernel_sk11:
    v_exp_f32 v16, v16
    s_waitcnt lgkmcnt(3)
    v_mfma_f32_32x32x16_bf16 v[56:71], v[108:111], v[52:55], v[56:71]
    ds_read_b128 v[108:111], v114 offset:20096
    v_exp_f32 v17, v17
    v_exp_f32 v18, v18
    v_exp_f32 v19, v19
    v_cvt_pk_bf16_f32 v48, v16, v17
    s_waitcnt lgkmcnt(3)
    v_mfma_f32_32x32x16_bf16 v[32:47], v[96:99], v[88:91], 0
    ds_read_b128 v[96:99], v112 offset:24320
    v_exp_f32 v20, v20
    v_exp_f32 v21, v21
    v_cvt_pk_bf16_f32 v49, v18, v19
    v_exp_f32 v22, v22
    v_exp_f32 v23, v23
    v_cvt_pk_bf16_f32 v50, v20, v21
    s_waitcnt lgkmcnt(3)
    v_mfma_f32_32x32x8bf16_1k v[32:47], v[100:101], v[92:93], v[32:47]
    ds_read_b32 v100, v113 offset:24320
    v_exp_f32 v24, v24
    v_exp_f32 v25, v25
    v_cvt_pk_bf16_f32 v51, v22, v23
    v_exp_f32 v26, v26
    v_exp_f32 v27, v27
    v_cvt_pk_bf16_f32 v52, v24, v25
    s_waitcnt lgkmcnt(3)
    v_mfma_f32_32x32x16_bf16 v[56:71], v[104:107], v[48:51], v[56:71]
    ds_read_b128 v[104:107], v114 offset:21888
    v_exp_f32 v28, v28
    v_exp_f32 v29, v29
    v_cvt_pk_bf16_f32 v53, v26, v27
    v_exp_f32 v30, v30
    v_exp_f32 v31, v31
    v_cvt_pk_bf16_f32 v54, v28, v29
    v_cvt_pk_bf16_f32 v55, v30, v31
    v_exp_f32 v32, v32
    s_waitcnt lgkmcnt(3)
    v_mfma_f32_32x32x16_bf16 v[56:71], v[108:111], v[52:55], v[56:71]
    ds_read_b128 v[108:111], v114 offset:22528
    v_exp_f32 v33, v33
    v_exp_f32 v34, v34
    v_exp_f32 v35, v35
    v_cvt_pk_bf16_f32 v48, v32, v33
    s_waitcnt lgkmcnt(3)
    v_mfma_f32_32x32x16_bf16 v[16:31], v[96:99], v[88:91], 0
    ds_read_b128 v[96:99], v112 offset:26752
    v_exp_f32 v36, v36
    v_exp_f32 v37, v37
    v_cvt_pk_bf16_f32 v49, v34, v35
    v_exp_f32 v38, v38
    v_exp_f32 v39, v39
    v_cvt_pk_bf16_f32 v50, v36, v37
    s_waitcnt lgkmcnt(3)
    v_mfma_f32_32x32x8bf16_1k v[16:31], v[100:101], v[92:93], v[16:31]
    ds_read_b32 v100, v113 offset:26752
    v_exp_f32 v40, v40
    v_exp_f32 v41, v41
    v_cvt_pk_bf16_f32 v51, v38, v39
    v_exp_f32 v42, v42
    v_exp_f32 v43, v43
    v_cvt_pk_bf16_f32 v52, v40, v41
    s_waitcnt lgkmcnt(3)
    v_mfma_f32_32x32x16_bf16 v[56:71], v[104:107], v[48:51], v[56:71]
    ds_read_b128 v[104:107], v114 offset:24320
    v_exp_f32 v44, v44
    v_exp_f32 v45, v45
    v_cvt_pk_bf16_f32 v53, v42, v43
    v_exp_f32 v46, v46
    v_exp_f32 v47, v47
    v_cvt_pk_bf16_f32 v54, v44, v45
    v_cvt_pk_bf16_f32 v55, v46, v47
    v_exp_f32 v16, v16
    s_waitcnt lgkmcnt(3)
    v_mfma_f32_32x32x16_bf16 v[56:71], v[108:111], v[52:55], v[56:71]
    ds_read_b128 v[108:111], v114 offset:24960
    v_exp_f32 v17, v17
    v_exp_f32 v18, v18
    v_exp_f32 v19, v19
    v_cvt_pk_bf16_f32 v48, v16, v17
    s_waitcnt lgkmcnt(3)
    v_mfma_f32_32x32x16_bf16 v[32:47], v[96:99], v[88:91], 0
    ds_read_b128 v[96:99], v112 offset:29184
    v_exp_f32 v20, v20
    v_exp_f32 v21, v21
    v_cvt_pk_bf16_f32 v49, v18, v19
    v_exp_f32 v22, v22
    v_exp_f32 v23, v23
    v_cvt_pk_bf16_f32 v50, v20, v21
    s_waitcnt lgkmcnt(3)
    v_mfma_f32_32x32x8bf16_1k v[32:47], v[100:101], v[92:93], v[32:47]
    ds_read_b32 v100, v113 offset:29184
    v_exp_f32 v24, v24
    v_exp_f32 v25, v25
    v_cvt_pk_bf16_f32 v51, v22, v23
    v_exp_f32 v26, v26
    v_exp_f32 v27, v27
    v_cvt_pk_bf16_f32 v52, v24, v25
    s_waitcnt lgkmcnt(3)
    v_mfma_f32_32x32x16_bf16 v[56:71], v[104:107], v[48:51], v[56:71]
    ds_read_b128 v[104:107], v114 offset:26752
    v_exp_f32 v28, v28
    v_exp_f32 v29, v29
    v_cvt_pk_bf16_f32 v53, v26, v27
    v_exp_f32 v30, v30
    v_exp_f32 v31, v31
    v_cvt_pk_bf16_f32 v54, v28, v29
    v_cvt_pk_bf16_f32 v55, v30, v31
    v_exp_f32 v32, v32
    s_waitcnt lgkmcnt(3)
    v_mfma_f32_32x32x16_bf16 v[56:71], v[108:111], v[52:55], v[56:71]
    ds_read_b128 v[108:111], v114 offset:27392
    v_exp_f32 v33, v33
    v_exp_f32 v34, v34
    v_exp_f32 v35, v35
    v_cvt_pk_bf16_f32 v48, v32, v33
    s_waitcnt lgkmcnt(3)
    v_mfma_f32_32x32x16_bf16 v[16:31], v[96:99], v[88:91], 0
    ds_read_b128 v[96:99], v112 offset:31616
    v_exp_f32 v36, v36
    v_exp_f32 v37, v37
    v_cvt_pk_bf16_f32 v49, v34, v35
    v_exp_f32 v38, v38
    v_exp_f32 v39, v39
    v_cvt_pk_bf16_f32 v50, v36, v37
    s_waitcnt lgkmcnt(3)
    v_mfma_f32_32x32x8bf16_1k v[16:31], v[100:101], v[92:93], v[16:31]
    ds_read_b32 v100, v113 offset:31616
    v_exp_f32 v40, v40
    v_exp_f32 v41, v41
    v_cvt_pk_bf16_f32 v51, v38, v39
    v_exp_f32 v42, v42
    v_exp_f32 v43, v43
    v_cvt_pk_bf16_f32 v52, v40, v41
    s_waitcnt lgkmcnt(3)
    v_mfma_f32_32x32x16_bf16 v[56:71], v[104:107], v[48:51], v[56:71]
    ds_read_b128 v[104:107], v114 offset:29184
    v_exp_f32 v44, v44
    v_exp_f32 v45, v45
    v_cvt_pk_bf16_f32 v53, v42, v43
    v_exp_f32 v46, v46
    v_exp_f32 v47, v47
    v_cvt_pk_bf16_f32 v54, v44, v45
    v_cvt_pk_bf16_f32 v55, v46, v47
    v_exp_f32 v16, v16
    s_waitcnt lgkmcnt(3)
    v_mfma_f32_32x32x16_bf16 v[56:71], v[108:111], v[52:55], v[56:71]
    ds_read_b128 v[108:111], v114 offset:29824
    v_exp_f32 v17, v17
    v_exp_f32 v18, v18
    v_exp_f32 v19, v19
    v_cvt_pk_bf16_f32 v48, v16, v17
    s_waitcnt lgkmcnt(3)
    v_mfma_f32_32x32x16_bf16 v[32:47], v[96:99], v[88:91], 0
    ds_read_b128 v[96:99], v112 offset:34048
    v_exp_f32 v20, v20
    v_exp_f32 v21, v21
    v_cvt_pk_bf16_f32 v49, v18, v19
    v_exp_f32 v22, v22
    v_exp_f32 v23, v23
    v_cvt_pk_bf16_f32 v50, v20, v21
    s_waitcnt lgkmcnt(3)
    v_mfma_f32_32x32x8bf16_1k v[32:47], v[100:101], v[92:93], v[32:47]
    ds_read_b32 v100, v113 offset:34048
    v_exp_f32 v24, v24
    v_exp_f32 v25, v25
    v_cvt_pk_bf16_f32 v51, v22, v23
    v_exp_f32 v26, v26
    v_exp_f32 v27, v27
    v_cvt_pk_bf16_f32 v52, v24, v25
    s_waitcnt lgkmcnt(3)
    v_mfma_f32_32x32x16_bf16 v[56:71], v[104:107], v[48:51], v[56:71]
    ds_read_b128 v[104:107], v114 offset:31616
    v_exp_f32 v28, v28
    v_exp_f32 v29, v29
    v_cvt_pk_bf16_f32 v53, v26, v27
    v_exp_f32 v30, v30
    v_exp_f32 v31, v31
    v_cvt_pk_bf16_f32 v54, v28, v29
    v_cvt_pk_bf16_f32 v55, v30, v31
    v_exp_f32 v32, v32
    s_waitcnt lgkmcnt(3)
    v_mfma_f32_32x32x16_bf16 v[56:71], v[108:111], v[52:55], v[56:71]
    ds_read_b128 v[108:111], v114 offset:32256
    v_exp_f32 v33, v33
    v_exp_f32 v34, v34
    v_exp_f32 v35, v35
    v_cvt_pk_bf16_f32 v48, v32, v33
    s_waitcnt lgkmcnt(3)
    v_mfma_f32_32x32x16_bf16 v[16:31], v[96:99], v[88:91], 0
    ds_read_b128 v[96:99], v112 offset:36480
    v_exp_f32 v36, v36
    v_exp_f32 v37, v37
    v_cvt_pk_bf16_f32 v49, v34, v35
    v_exp_f32 v38, v38
    v_exp_f32 v39, v39
    v_cvt_pk_bf16_f32 v50, v36, v37
    s_waitcnt lgkmcnt(3)
    v_mfma_f32_32x32x8bf16_1k v[16:31], v[100:101], v[92:93], v[16:31]
    ds_read_b32 v100, v113 offset:36480
    v_exp_f32 v40, v40
    v_exp_f32 v41, v41
    v_cvt_pk_bf16_f32 v51, v38, v39
    v_exp_f32 v42, v42
    v_exp_f32 v43, v43
    v_cvt_pk_bf16_f32 v52, v40, v41
    s_waitcnt lgkmcnt(3)
    v_mfma_f32_32x32x16_bf16 v[56:71], v[104:107], v[48:51], v[56:71]
    ds_read_b128 v[104:107], v114 offset:34048
    v_exp_f32 v44, v44
    v_exp_f32 v45, v45
    v_cvt_pk_bf16_f32 v53, v42, v43
    v_exp_f32 v46, v46
    v_exp_f32 v47, v47
    v_cvt_pk_bf16_f32 v54, v44, v45
    v_cvt_pk_bf16_f32 v55, v46, v47
    v_exp_f32 v16, v16
    s_waitcnt lgkmcnt(3)
    v_mfma_f32_32x32x16_bf16 v[56:71], v[108:111], v[52:55], v[56:71]
    ds_read_b128 v[108:111], v114 offset:34688
    v_exp_f32 v17, v17
    v_exp_f32 v18, v18
    v_exp_f32 v19, v19
    v_cvt_pk_bf16_f32 v48, v16, v17
    s_waitcnt lgkmcnt(3)
    v_mfma_f32_32x32x16_bf16 v[32:47], v[96:99], v[88:91], 0
    ds_read_b128 v[96:99], v112 offset:38912
    v_exp_f32 v20, v20
    v_exp_f32 v21, v21
    v_cvt_pk_bf16_f32 v49, v18, v19
    v_exp_f32 v22, v22
    v_exp_f32 v23, v23
    v_cvt_pk_bf16_f32 v50, v20, v21
    s_waitcnt lgkmcnt(3)
    v_mfma_f32_32x32x8bf16_1k v[32:47], v[100:101], v[92:93], v[32:47]
    ds_read_b32 v100, v113 offset:38912
    v_exp_f32 v24, v24
    v_exp_f32 v25, v25
    v_cvt_pk_bf16_f32 v51, v22, v23
    v_exp_f32 v26, v26
    v_exp_f32 v27, v27
    v_cvt_pk_bf16_f32 v52, v24, v25
    s_waitcnt lgkmcnt(3)
    v_mfma_f32_32x32x16_bf16 v[56:71], v[104:107], v[48:51], v[56:71]
    ds_read_b128 v[104:107], v114 offset:36480
    v_exp_f32 v28, v28
    v_exp_f32 v29, v29
    v_cvt_pk_bf16_f32 v53, v26, v27
    v_exp_f32 v30, v30
    v_exp_f32 v31, v31
    v_cvt_pk_bf16_f32 v54, v28, v29
    v_cvt_pk_bf16_f32 v55, v30, v31
    v_exp_f32 v32, v32
    s_waitcnt lgkmcnt(3)
    v_mfma_f32_32x32x16_bf16 v[56:71], v[108:111], v[52:55], v[56:71]
    ds_read_b128 v[108:111], v114 offset:37120
    v_exp_f32 v33, v33
    v_exp_f32 v34, v34
    v_exp_f32 v35, v35
    v_cvt_pk_bf16_f32 v48, v32, v33
    s_waitcnt lgkmcnt(3)
    v_mfma_f32_32x32x16_bf16 v[16:31], v[96:99], v[88:91], 0
    ds_read_b128 v[96:99], v112 offset:41344
    v_exp_f32 v36, v36
    v_exp_f32 v37, v37
    v_cvt_pk_bf16_f32 v49, v34, v35
    v_exp_f32 v38, v38
    v_exp_f32 v39, v39
    v_cvt_pk_bf16_f32 v50, v36, v37
    s_waitcnt lgkmcnt(3)
    v_mfma_f32_32x32x8bf16_1k v[16:31], v[100:101], v[92:93], v[16:31]
    ds_read_b32 v100, v113 offset:41344
    v_exp_f32 v40, v40
    v_exp_f32 v41, v41
    v_cvt_pk_bf16_f32 v51, v38, v39
    v_exp_f32 v42, v42
    v_exp_f32 v43, v43
    v_cvt_pk_bf16_f32 v52, v40, v41
    s_waitcnt lgkmcnt(3)
    v_mfma_f32_32x32x16_bf16 v[56:71], v[104:107], v[48:51], v[56:71]
    ds_read_b128 v[104:107], v114 offset:38912
    v_exp_f32 v44, v44
    v_exp_f32 v45, v45
    v_cvt_pk_bf16_f32 v53, v42, v43
    v_exp_f32 v46, v46
    v_exp_f32 v47, v47
    v_cvt_pk_bf16_f32 v54, v44, v45
    v_cvt_pk_bf16_f32 v55, v46, v47
    v_add_u32 v112, 38912, v112
    v_add_u32 v113, 38912, v113
    v_add_u32 v114, 38912, v114
    v_exp_f32 v16, v16
    s_waitcnt lgkmcnt(3)
    v_mfma_f32_32x32x16_bf16 v[56:71], v[108:111], v[52:55], v[56:71]
    ds_read_b128 v[108:111], v114 offset:640
    v_exp_f32 v17, v17
    v_exp_f32 v18, v18
    v_exp_f32 v19, v19
    v_cvt_pk_bf16_f32 v48, v16, v17
    s_waitcnt lgkmcnt(3)
    v_mfma_f32_32x32x16_bf16 v[32:47], v[96:99], v[88:91], 0
    ds_read_b128 v[96:99], v112 offset:4864
    v_exp_f32 v20, v20
    v_exp_f32 v21, v21
    v_cvt_pk_bf16_f32 v49, v18, v19
    v_exp_f32 v22, v22
    v_exp_f32 v23, v23
    v_cvt_pk_bf16_f32 v50, v20, v21
    s_waitcnt lgkmcnt(3)
    v_mfma_f32_32x32x8bf16_1k v[32:47], v[100:101], v[92:93], v[32:47]
    ds_read_b32 v100, v113 offset:4864
    v_exp_f32 v24, v24
    v_exp_f32 v25, v25
    v_cvt_pk_bf16_f32 v51, v22, v23
    v_exp_f32 v26, v26
    v_exp_f32 v27, v27
    v_cvt_pk_bf16_f32 v52, v24, v25
    s_waitcnt lgkmcnt(3)
    v_mfma_f32_32x32x16_bf16 v[56:71], v[104:107], v[48:51], v[56:71]
    ds_read_b128 v[104:107], v114 offset:2432
    v_exp_f32 v28, v28
    v_exp_f32 v29, v29
    v_cvt_pk_bf16_f32 v53, v26, v27
    v_exp_f32 v30, v30
    v_exp_f32 v31, v31
    v_cvt_pk_bf16_f32 v54, v28, v29
    v_cvt_pk_bf16_f32 v55, v30, v31
    v_exp_f32 v32, v32
    s_waitcnt lgkmcnt(3)
    v_mfma_f32_32x32x16_bf16 v[56:71], v[108:111], v[52:55], v[56:71]
    ds_read_b128 v[108:111], v114 offset:3072
    v_exp_f32 v33, v33
    v_exp_f32 v34, v34
    v_exp_f32 v35, v35
    v_cvt_pk_bf16_f32 v48, v32, v33
    s_waitcnt lgkmcnt(3)
    v_mfma_f32_32x32x16_bf16 v[16:31], v[96:99], v[88:91], 0
    ds_read_b128 v[96:99], v112 offset:7296
    v_exp_f32 v36, v36
    v_exp_f32 v37, v37
    v_cvt_pk_bf16_f32 v49, v34, v35
    v_exp_f32 v38, v38
    v_exp_f32 v39, v39
    v_cvt_pk_bf16_f32 v50, v36, v37
    s_waitcnt lgkmcnt(3)
    v_mfma_f32_32x32x8bf16_1k v[16:31], v[100:101], v[92:93], v[16:31]
    ds_read_b32 v100, v113 offset:7296
    v_exp_f32 v40, v40
    v_exp_f32 v41, v41
    v_cvt_pk_bf16_f32 v51, v38, v39
    v_exp_f32 v42, v42
    v_exp_f32 v43, v43
    v_cvt_pk_bf16_f32 v52, v40, v41
    s_waitcnt lgkmcnt(3)
    v_mfma_f32_32x32x16_bf16 v[56:71], v[104:107], v[48:51], v[56:71]
    ds_read_b128 v[104:107], v114 offset:4864
    v_exp_f32 v44, v44
    v_exp_f32 v45, v45
    v_cvt_pk_bf16_f32 v53, v42, v43
    v_exp_f32 v46, v46
    v_exp_f32 v47, v47
    v_cvt_pk_bf16_f32 v54, v44, v45
    v_cvt_pk_bf16_f32 v55, v46, v47
    v_exp_f32 v16, v16
    s_waitcnt lgkmcnt(3)
    v_mfma_f32_32x32x16_bf16 v[56:71], v[108:111], v[52:55], v[56:71]
    ds_read_b128 v[108:111], v114 offset:5504
    v_exp_f32 v17, v17
    v_exp_f32 v18, v18
    v_exp_f32 v19, v19
    v_cvt_pk_bf16_f32 v48, v16, v17
    s_waitcnt lgkmcnt(3)
    v_mfma_f32_32x32x16_bf16 v[32:47], v[96:99], v[88:91], 0
    ds_read_b128 v[96:99], v112 offset:9728
    v_exp_f32 v20, v20
    v_exp_f32 v21, v21
    v_cvt_pk_bf16_f32 v49, v18, v19
    v_exp_f32 v22, v22
    v_exp_f32 v23, v23
    v_cvt_pk_bf16_f32 v50, v20, v21
    s_waitcnt lgkmcnt(3)
    v_mfma_f32_32x32x8bf16_1k v[32:47], v[100:101], v[92:93], v[32:47]
    ds_read_b32 v100, v113 offset:9728
    v_exp_f32 v24, v24
    v_exp_f32 v25, v25
    v_cvt_pk_bf16_f32 v51, v22, v23
    v_exp_f32 v26, v26
    v_exp_f32 v27, v27
    v_cvt_pk_bf16_f32 v52, v24, v25
    s_waitcnt lgkmcnt(3)
    v_mfma_f32_32x32x16_bf16 v[56:71], v[104:107], v[48:51], v[56:71]
    ds_read_b128 v[104:107], v114 offset:7296
    v_exp_f32 v28, v28
    v_exp_f32 v29, v29
    v_cvt_pk_bf16_f32 v53, v26, v27
    v_exp_f32 v30, v30
    v_exp_f32 v31, v31
    v_cvt_pk_bf16_f32 v54, v28, v29
    v_cvt_pk_bf16_f32 v55, v30, v31
    v_exp_f32 v32, v32
    s_waitcnt lgkmcnt(3)
    v_mfma_f32_32x32x16_bf16 v[56:71], v[108:111], v[52:55], v[56:71]
    ds_read_b128 v[108:111], v114 offset:7936
    v_exp_f32 v33, v33
    v_exp_f32 v34, v34
    v_exp_f32 v35, v35
    v_cvt_pk_bf16_f32 v48, v32, v33
    s_waitcnt lgkmcnt(3)
    v_mfma_f32_32x32x16_bf16 v[16:31], v[96:99], v[88:91], 0
    ds_read_b128 v[96:99], v112 offset:12160
    v_exp_f32 v36, v36
    v_exp_f32 v37, v37
    v_cvt_pk_bf16_f32 v49, v34, v35
    v_exp_f32 v38, v38
    v_exp_f32 v39, v39
    v_cvt_pk_bf16_f32 v50, v36, v37
    s_waitcnt lgkmcnt(3)
    v_mfma_f32_32x32x8bf16_1k v[16:31], v[100:101], v[92:93], v[16:31]
    ds_read_b32 v100, v113 offset:12160
    v_exp_f32 v40, v40
    v_exp_f32 v41, v41
    v_cvt_pk_bf16_f32 v51, v38, v39
    v_exp_f32 v42, v42
    v_exp_f32 v43, v43
    v_cvt_pk_bf16_f32 v52, v40, v41
    s_waitcnt lgkmcnt(3)
    v_mfma_f32_32x32x16_bf16 v[56:71], v[104:107], v[48:51], v[56:71]
    ds_read_b128 v[104:107], v114 offset:9728
    v_exp_f32 v44, v44
    v_exp_f32 v45, v45
    v_cvt_pk_bf16_f32 v53, v42, v43
    v_exp_f32 v46, v46
    v_exp_f32 v47, v47
    v_cvt_pk_bf16_f32 v54, v44, v45
    v_cvt_pk_bf16_f32 v55, v46, v47
    v_exp_f32 v16, v16
    s_waitcnt lgkmcnt(3)
    v_mfma_f32_32x32x16_bf16 v[56:71], v[108:111], v[52:55], v[56:71]
    ds_read_b128 v[108:111], v114 offset:10368
    v_exp_f32 v17, v17
    v_exp_f32 v18, v18
    v_exp_f32 v19, v19
    v_cvt_pk_bf16_f32 v48, v16, v17
    s_waitcnt lgkmcnt(3)
    v_mfma_f32_32x32x16_bf16 v[32:47], v[96:99], v[88:91], 0
    ds_read_b128 v[96:99], v112 offset:14592
    v_exp_f32 v20, v20
    v_exp_f32 v21, v21
    v_cvt_pk_bf16_f32 v49, v18, v19
    v_exp_f32 v22, v22
    v_exp_f32 v23, v23
    v_cvt_pk_bf16_f32 v50, v20, v21
    s_waitcnt lgkmcnt(3)
    v_mfma_f32_32x32x8bf16_1k v[32:47], v[100:101], v[92:93], v[32:47]
    ds_read_b32 v100, v113 offset:14592
    v_exp_f32 v24, v24
    v_exp_f32 v25, v25
    v_cvt_pk_bf16_f32 v51, v22, v23
    v_exp_f32 v26, v26
    v_exp_f32 v27, v27
    v_cvt_pk_bf16_f32 v52, v24, v25
    s_waitcnt lgkmcnt(3)
    v_mfma_f32_32x32x16_bf16 v[56:71], v[104:107], v[48:51], v[56:71]
    ds_read_b128 v[104:107], v114 offset:12160
    v_exp_f32 v28, v28
    v_exp_f32 v29, v29
    v_cvt_pk_bf16_f32 v53, v26, v27
    v_exp_f32 v30, v30
    v_exp_f32 v31, v31
    v_cvt_pk_bf16_f32 v54, v28, v29
    v_cvt_pk_bf16_f32 v55, v30, v31
    v_exp_f32 v32, v32
    s_waitcnt lgkmcnt(3)
    v_mfma_f32_32x32x16_bf16 v[56:71], v[108:111], v[52:55], v[56:71]
    ds_read_b128 v[108:111], v114 offset:12800
    v_exp_f32 v33, v33
    v_exp_f32 v34, v34
    v_exp_f32 v35, v35
    v_cvt_pk_bf16_f32 v48, v32, v33
    s_waitcnt lgkmcnt(3)
    v_mfma_f32_32x32x16_bf16 v[16:31], v[96:99], v[88:91], 0
    ds_read_b128 v[96:99], v112 offset:17024
    v_exp_f32 v36, v36
    v_exp_f32 v37, v37
    v_cvt_pk_bf16_f32 v49, v34, v35
    v_exp_f32 v38, v38
    v_exp_f32 v39, v39
    v_cvt_pk_bf16_f32 v50, v36, v37
    s_waitcnt lgkmcnt(3)
    v_mfma_f32_32x32x8bf16_1k v[16:31], v[100:101], v[92:93], v[16:31]
    ds_read_b32 v100, v113 offset:17024
    v_exp_f32 v40, v40
    v_exp_f32 v41, v41
    v_cvt_pk_bf16_f32 v51, v38, v39
    v_exp_f32 v42, v42
    v_exp_f32 v43, v43
    v_cvt_pk_bf16_f32 v52, v40, v41
    s_waitcnt lgkmcnt(3)
    v_mfma_f32_32x32x16_bf16 v[56:71], v[104:107], v[48:51], v[56:71]
    ds_read_b128 v[104:107], v114 offset:14592
    v_exp_f32 v44, v44
    v_exp_f32 v45, v45
    v_cvt_pk_bf16_f32 v53, v42, v43
    v_exp_f32 v46, v46
    v_exp_f32 v47, v47
    v_cvt_pk_bf16_f32 v54, v44, v45
    v_cvt_pk_bf16_f32 v55, v46, v47
    v_exp_f32 v16, v16
    s_waitcnt lgkmcnt(3)
    v_mfma_f32_32x32x16_bf16 v[56:71], v[108:111], v[52:55], v[56:71]
    ds_read_b128 v[108:111], v114 offset:15232
    v_exp_f32 v17, v17
    v_exp_f32 v18, v18
    v_exp_f32 v19, v19
    v_cvt_pk_bf16_f32 v48, v16, v17
    s_waitcnt lgkmcnt(3)
    v_mfma_f32_32x32x16_bf16 v[32:47], v[96:99], v[88:91], 0
    ds_read_b128 v[96:99], v112 offset:19456
    v_exp_f32 v20, v20
    v_exp_f32 v21, v21
    v_cvt_pk_bf16_f32 v49, v18, v19
    v_exp_f32 v22, v22
    v_exp_f32 v23, v23
    v_cvt_pk_bf16_f32 v50, v20, v21
    s_waitcnt lgkmcnt(3)
    v_mfma_f32_32x32x8bf16_1k v[32:47], v[100:101], v[92:93], v[32:47]
    ds_read_b32 v100, v113 offset:19456
    v_exp_f32 v24, v24
    v_exp_f32 v25, v25
    v_cvt_pk_bf16_f32 v51, v22, v23
    v_exp_f32 v26, v26
    v_exp_f32 v27, v27
    v_cvt_pk_bf16_f32 v52, v24, v25
    s_waitcnt lgkmcnt(3)
    v_mfma_f32_32x32x16_bf16 v[56:71], v[104:107], v[48:51], v[56:71]
    ds_read_b128 v[104:107], v114 offset:17024
    v_exp_f32 v28, v28
    v_exp_f32 v29, v29
    v_cvt_pk_bf16_f32 v53, v26, v27
    v_exp_f32 v30, v30
    v_exp_f32 v31, v31
    v_cvt_pk_bf16_f32 v54, v28, v29
    v_cvt_pk_bf16_f32 v55, v30, v31
    v_exp_f32 v32, v32
    s_waitcnt lgkmcnt(3)
    v_mfma_f32_32x32x16_bf16 v[56:71], v[108:111], v[52:55], v[56:71]
    ds_read_b128 v[108:111], v114 offset:17664
    v_exp_f32 v33, v33
    v_exp_f32 v34, v34
    v_exp_f32 v35, v35
    v_cvt_pk_bf16_f32 v48, v32, v33
    s_waitcnt lgkmcnt(3)
    v_mfma_f32_32x32x16_bf16 v[16:31], v[96:99], v[88:91], 0
    ds_read_b128 v[96:99], v112 offset:21888
    v_exp_f32 v36, v36
    v_exp_f32 v37, v37
    v_cvt_pk_bf16_f32 v49, v34, v35
    v_exp_f32 v38, v38
    v_exp_f32 v39, v39
    v_cvt_pk_bf16_f32 v50, v36, v37
    s_waitcnt lgkmcnt(3)
    v_mfma_f32_32x32x8bf16_1k v[16:31], v[100:101], v[92:93], v[16:31]
    ds_read_b32 v100, v113 offset:21888
    v_exp_f32 v40, v40
    v_exp_f32 v41, v41
    v_cvt_pk_bf16_f32 v51, v38, v39
    v_exp_f32 v42, v42
    v_exp_f32 v43, v43
    v_cvt_pk_bf16_f32 v52, v40, v41
    s_waitcnt lgkmcnt(3)
    v_mfma_f32_32x32x16_bf16 v[56:71], v[104:107], v[48:51], v[56:71]
    ds_read_b128 v[104:107], v114 offset:19456
    v_exp_f32 v44, v44
    v_exp_f32 v45, v45
    v_cvt_pk_bf16_f32 v53, v42, v43
    v_exp_f32 v46, v46
    v_exp_f32 v47, v47
    v_cvt_pk_bf16_f32 v54, v44, v45
    v_cvt_pk_bf16_f32 v55, v46, v47
    s_setprio 2
    v_exp_f32 v16, v16
    s_waitcnt lgkmcnt(3)
    v_mfma_f32_32x32x16_bf16 v[56:71], v[108:111], v[52:55], v[56:71]
    ds_read_b128 v[108:111], v114 offset:20096
    v_exp_f32 v17, v17
    v_exp_f32 v18, v18
    v_exp_f32 v19, v19
    v_cvt_pk_bf16_f32 v48, v16, v17
    s_waitcnt lgkmcnt(3)
    v_mfma_f32_32x32x16_bf16 v[32:47], v[96:99], v[88:91], 0
    ds_read_b128 v[96:99], v112 offset:24320
    v_exp_f32 v20, v20
    v_exp_f32 v21, v21
    v_cvt_pk_bf16_f32 v49, v18, v19
    v_exp_f32 v22, v22
    v_exp_f32 v23, v23
    v_cvt_pk_bf16_f32 v50, v20, v21
    s_waitcnt lgkmcnt(3)
    v_mfma_f32_32x32x8bf16_1k v[32:47], v[100:101], v[92:93], v[32:47]
    ds_read_b32 v100, v113 offset:24320
    v_exp_f32 v24, v24
    v_exp_f32 v25, v25
    v_cvt_pk_bf16_f32 v51, v22, v23
    v_exp_f32 v26, v26
    v_exp_f32 v27, v27
    v_cvt_pk_bf16_f32 v52, v24, v25
    s_waitcnt lgkmcnt(3)
    v_mfma_f32_32x32x16_bf16 v[56:71], v[104:107], v[48:51], v[56:71]
    ds_read_b128 v[104:107], v114 offset:21888
    v_exp_f32 v28, v28
    v_exp_f32 v29, v29
    v_cvt_pk_bf16_f32 v53, v26, v27
    v_exp_f32 v30, v30
    v_exp_f32 v31, v31
    v_cvt_pk_bf16_f32 v54, v28, v29
    v_cvt_pk_bf16_f32 v55, v30, v31
    v_exp_f32 v32, v32
    s_waitcnt lgkmcnt(3)
    v_mfma_f32_32x32x16_bf16 v[56:71], v[108:111], v[52:55], v[56:71]
    ds_read_b128 v[108:111], v114 offset:22528
    v_exp_f32 v33, v33
    v_exp_f32 v34, v34
    v_exp_f32 v35, v35
    v_cvt_pk_bf16_f32 v48, v32, v33
    s_waitcnt lgkmcnt(3)
    v_mfma_f32_32x32x16_bf16 v[16:31], v[96:99], v[88:91], 0
    ds_read_b128 v[96:99], v112 offset:26752
    v_exp_f32 v36, v36
    v_exp_f32 v37, v37
    v_cvt_pk_bf16_f32 v49, v34, v35
    v_exp_f32 v38, v38
    v_exp_f32 v39, v39
    v_cvt_pk_bf16_f32 v50, v36, v37
    s_waitcnt lgkmcnt(3)
    v_mfma_f32_32x32x8bf16_1k v[16:31], v[100:101], v[92:93], v[16:31]
    ds_read_b32 v100, v113 offset:26752
    v_exp_f32 v40, v40
    v_exp_f32 v41, v41
    v_cvt_pk_bf16_f32 v51, v38, v39
    v_exp_f32 v42, v42
    v_exp_f32 v43, v43
    v_cvt_pk_bf16_f32 v52, v40, v41
    s_waitcnt lgkmcnt(3)
    v_mfma_f32_32x32x16_bf16 v[56:71], v[104:107], v[48:51], v[56:71]
    ds_read_b128 v[104:107], v114 offset:24320
    v_exp_f32 v44, v44
    v_exp_f32 v45, v45
    v_cvt_pk_bf16_f32 v53, v42, v43
    v_exp_f32 v46, v46
    v_exp_f32 v47, v47
    v_cvt_pk_bf16_f32 v54, v44, v45
    v_cvt_pk_bf16_f32 v55, v46, v47
    v_exp_f32 v16, v16
    s_waitcnt lgkmcnt(3)
    v_mfma_f32_32x32x16_bf16 v[56:71], v[108:111], v[52:55], v[56:71]
    ds_read_b128 v[108:111], v114 offset:24960
    v_exp_f32 v17, v17
    v_exp_f32 v18, v18
    v_exp_f32 v19, v19
    v_cvt_pk_bf16_f32 v48, v16, v17
    s_waitcnt lgkmcnt(3)
    v_mfma_f32_32x32x16_bf16 v[32:47], v[96:99], v[88:91], 0
    ds_read_b128 v[96:99], v112 offset:29184
    v_exp_f32 v20, v20
    v_exp_f32 v21, v21
    v_cvt_pk_bf16_f32 v49, v18, v19
    v_exp_f32 v22, v22
    v_exp_f32 v23, v23
    v_cvt_pk_bf16_f32 v50, v20, v21
    s_waitcnt lgkmcnt(3)
    v_mfma_f32_32x32x8bf16_1k v[32:47], v[100:101], v[92:93], v[32:47]
    ds_read_b32 v100, v113 offset:29184
    v_exp_f32 v24, v24
    v_exp_f32 v25, v25
    v_cvt_pk_bf16_f32 v51, v22, v23
    v_exp_f32 v26, v26
    v_exp_f32 v27, v27
    v_cvt_pk_bf16_f32 v52, v24, v25
    s_waitcnt lgkmcnt(3)
    v_mfma_f32_32x32x16_bf16 v[56:71], v[104:107], v[48:51], v[56:71]
    ds_read_b128 v[104:107], v114 offset:26752
    v_exp_f32 v28, v28
    v_exp_f32 v29, v29
    v_cvt_pk_bf16_f32 v53, v26, v27
    v_exp_f32 v30, v30
    v_exp_f32 v31, v31
    v_cvt_pk_bf16_f32 v54, v28, v29
    v_cvt_pk_bf16_f32 v55, v30, v31
    v_exp_f32 v32, v32
    s_waitcnt lgkmcnt(3)
    v_mfma_f32_32x32x16_bf16 v[56:71], v[108:111], v[52:55], v[56:71]
    ds_read_b128 v[108:111], v114 offset:27392
    v_exp_f32 v33, v33
    v_exp_f32 v34, v34
    v_exp_f32 v35, v35
    v_cvt_pk_bf16_f32 v48, v32, v33
    s_waitcnt lgkmcnt(3)
    v_mfma_f32_32x32x16_bf16 v[16:31], v[96:99], v[88:91], 0
    ds_read_b128 v[96:99], v112 offset:31616
    v_exp_f32 v36, v36
    v_exp_f32 v37, v37
    v_cvt_pk_bf16_f32 v49, v34, v35
    v_exp_f32 v38, v38
    v_exp_f32 v39, v39
    v_cvt_pk_bf16_f32 v50, v36, v37
    s_waitcnt lgkmcnt(3)
    v_mfma_f32_32x32x8bf16_1k v[16:31], v[100:101], v[92:93], v[16:31]
    ds_read_b32 v100, v113 offset:31616
    v_exp_f32 v40, v40
    v_exp_f32 v41, v41
    v_cvt_pk_bf16_f32 v51, v38, v39
    v_exp_f32 v42, v42
    v_exp_f32 v43, v43
    v_cvt_pk_bf16_f32 v52, v40, v41
    s_waitcnt lgkmcnt(3)
    v_mfma_f32_32x32x16_bf16 v[56:71], v[104:107], v[48:51], v[56:71]
    ds_read_b128 v[104:107], v114 offset:29184
    v_exp_f32 v44, v44
    v_exp_f32 v45, v45
    v_cvt_pk_bf16_f32 v53, v42, v43
    v_exp_f32 v46, v46
    v_exp_f32 v47, v47
    v_cvt_pk_bf16_f32 v54, v44, v45
    v_cvt_pk_bf16_f32 v55, v46, v47
    s_setprio 1
    v_exp_f32 v16, v16
    s_waitcnt lgkmcnt(3)
    v_mfma_f32_32x32x16_bf16 v[56:71], v[108:111], v[52:55], v[56:71]
    ds_read_b128 v[108:111], v114 offset:29824
    v_exp_f32 v17, v17
    v_exp_f32 v18, v18
    v_exp_f32 v19, v19
    v_cvt_pk_bf16_f32 v48, v16, v17
    s_waitcnt lgkmcnt(3)
    v_mfma_f32_32x32x16_bf16 v[32:47], v[96:99], v[88:91], 0
    ds_read_b128 v[96:99], v112 offset:34048
    v_exp_f32 v20, v20
    v_exp_f32 v21, v21
    v_cvt_pk_bf16_f32 v49, v18, v19
    v_exp_f32 v22, v22
    v_exp_f32 v23, v23
    v_cvt_pk_bf16_f32 v50, v20, v21
    s_waitcnt lgkmcnt(3)
    v_mfma_f32_32x32x8bf16_1k v[32:47], v[100:101], v[92:93], v[32:47]
    ds_read_b32 v100, v113 offset:34048
    v_exp_f32 v24, v24
    v_exp_f32 v25, v25
    v_cvt_pk_bf16_f32 v51, v22, v23
    v_exp_f32 v26, v26
    v_exp_f32 v27, v27
    v_cvt_pk_bf16_f32 v52, v24, v25
    s_waitcnt lgkmcnt(3)
    v_mfma_f32_32x32x16_bf16 v[56:71], v[104:107], v[48:51], v[56:71]
    ds_read_b128 v[104:107], v114 offset:31616
    v_exp_f32 v28, v28
    v_exp_f32 v29, v29
    v_cvt_pk_bf16_f32 v53, v26, v27
    v_exp_f32 v30, v30
    v_exp_f32 v31, v31
    v_cvt_pk_bf16_f32 v54, v28, v29
    v_cvt_pk_bf16_f32 v55, v30, v31
    v_exp_f32 v32, v32
    s_waitcnt lgkmcnt(3)
    v_mfma_f32_32x32x16_bf16 v[56:71], v[108:111], v[52:55], v[56:71]
    ds_read_b128 v[108:111], v114 offset:32256
    v_exp_f32 v33, v33
    v_exp_f32 v34, v34
    v_exp_f32 v35, v35
    v_cvt_pk_bf16_f32 v48, v32, v33
    s_waitcnt lgkmcnt(3)
    v_mfma_f32_32x32x16_bf16 v[16:31], v[96:99], v[88:91], 0
    ds_read_b128 v[96:99], v112 offset:36480
    v_exp_f32 v36, v36
    v_exp_f32 v37, v37
    v_cvt_pk_bf16_f32 v49, v34, v35
    v_exp_f32 v38, v38
    v_exp_f32 v39, v39
    v_cvt_pk_bf16_f32 v50, v36, v37
    s_waitcnt lgkmcnt(3)
    v_mfma_f32_32x32x8bf16_1k v[16:31], v[100:101], v[92:93], v[16:31]
    ds_read_b32 v100, v113 offset:36480
    v_exp_f32 v40, v40
    v_exp_f32 v41, v41
    v_cvt_pk_bf16_f32 v51, v38, v39
    v_exp_f32 v42, v42
    v_exp_f32 v43, v43
    v_cvt_pk_bf16_f32 v52, v40, v41
    s_waitcnt lgkmcnt(3)
    v_mfma_f32_32x32x16_bf16 v[56:71], v[104:107], v[48:51], v[56:71]
    ds_read_b128 v[104:107], v114 offset:34048
    v_exp_f32 v44, v44
    v_exp_f32 v45, v45
    v_cvt_pk_bf16_f32 v53, v42, v43
    v_exp_f32 v46, v46
    v_exp_f32 v47, v47
    v_cvt_pk_bf16_f32 v54, v44, v45
    v_cvt_pk_bf16_f32 v55, v46, v47
    s_setprio 0
    v_exp_f32 v16, v16
    s_waitcnt lgkmcnt(3)
    v_mfma_f32_32x32x16_bf16 v[56:71], v[108:111], v[52:55], v[56:71]
    ds_read_b128 v[108:111], v114 offset:34688
    v_exp_f32 v17, v17
    v_exp_f32 v18, v18
    v_exp_f32 v19, v19
    v_cvt_pk_bf16_f32 v48, v16, v17
    s_waitcnt lgkmcnt(3)
    v_mfma_f32_32x32x16_bf16 v[32:47], v[96:99], v[88:91], 0
    ds_read_b128 v[96:99], v112 offset:38912
    v_exp_f32 v20, v20
    v_exp_f32 v21, v21
    v_cvt_pk_bf16_f32 v49, v18, v19
    v_exp_f32 v22, v22
    v_exp_f32 v23, v23
    v_cvt_pk_bf16_f32 v50, v20, v21
    s_waitcnt lgkmcnt(3)
    v_mfma_f32_32x32x8bf16_1k v[32:47], v[100:101], v[92:93], v[32:47]
    ds_read_b32 v100, v113 offset:38912
    v_exp_f32 v24, v24
    v_exp_f32 v25, v25
    v_cvt_pk_bf16_f32 v51, v22, v23
    v_exp_f32 v26, v26
    v_exp_f32 v27, v27
    v_cvt_pk_bf16_f32 v52, v24, v25
    s_waitcnt lgkmcnt(3)
    v_mfma_f32_32x32x16_bf16 v[56:71], v[104:107], v[48:51], v[56:71]
    ds_read_b128 v[104:107], v114 offset:36480
    v_exp_f32 v28, v28
    v_exp_f32 v29, v29
    v_cvt_pk_bf16_f32 v53, v26, v27
    v_exp_f32 v30, v30
    v_exp_f32 v31, v31
    v_cvt_pk_bf16_f32 v54, v28, v29
    v_cvt_pk_bf16_f32 v55, v30, v31
    v_exp_f32 v32, v32
    s_waitcnt lgkmcnt(3)
    v_mfma_f32_32x32x16_bf16 v[56:71], v[108:111], v[52:55], v[56:71]
    ds_read_b128 v[108:111], v114 offset:37120
    v_exp_f32 v33, v33
    v_exp_f32 v34, v34
    v_exp_f32 v35, v35
    v_cvt_pk_bf16_f32 v48, v32, v33
    s_waitcnt lgkmcnt(3)
    v_mfma_f32_32x32x16_bf16 v[16:31], v[96:99], v[88:91], 0
    ds_read_b128 v[96:99], v112 offset:41344
    v_exp_f32 v36, v36
    v_exp_f32 v37, v37
    v_cvt_pk_bf16_f32 v49, v34, v35
    v_exp_f32 v38, v38
    v_exp_f32 v39, v39
    v_cvt_pk_bf16_f32 v50, v36, v37
    s_waitcnt lgkmcnt(3)
    v_mfma_f32_32x32x8bf16_1k v[16:31], v[100:101], v[92:93], v[16:31]
    ds_read_b32 v100, v113 offset:41344
    v_exp_f32 v40, v40
    v_exp_f32 v41, v41
    v_cvt_pk_bf16_f32 v51, v38, v39
    v_exp_f32 v42, v42
    v_exp_f32 v43, v43
    v_cvt_pk_bf16_f32 v52, v40, v41
    s_waitcnt lgkmcnt(3)
    v_mfma_f32_32x32x16_bf16 v[56:71], v[104:107], v[48:51], v[56:71]
    ds_read_b128 v[104:107], v114 offset:38912
    v_exp_f32 v44, v44
    v_exp_f32 v45, v45
    v_cvt_pk_bf16_f32 v53, v42, v43
    v_exp_f32 v46, v46
    v_exp_f32 v47, v47
    v_cvt_pk_bf16_f32 v54, v44, v45
    v_cvt_pk_bf16_f32 v55, v46, v47
    s_waitcnt lgkmcnt(3)
    s_nop 0
    v_mfma_f32_32x32x16_bf16 v[56:71], v[108:111], v[52:55], v[56:71]
    s_waitcnt vmcnt(0) lgkmcnt(0)
    s_nop 7
    s_nop 7
    v_max3_f32 v10, |v56|, |v57|, |v58|
    v_max3_f32 v10, v10, |v59|, |v60|
    v_max3_f32 v10, v10, |v61|, |v62|
    v_max3_f32 v10, v10, |v63|, |v64|
    v_max3_f32 v10, v10, |v65|, |v66|
    v_max_f32 v10, v10, |v67|
    v_add_f32 v11, v56, v57
    v_add_f32 v11, v11, v58
    v_add_f32 v11, v11, v59
    v_add_f32 v11, v11, v60
    v_add_f32 v11, v11, v61
    v_add_f32 v11, v11, v62
    v_add_f32 v11, v11, v63
    v_add_f32 v11, v11, v64
    v_add_f32 v11, v11, v65
    v_add_f32 v11, v11, v66
    v_add_f32 v11, v11, v67
    v_mov_b32 v12, 0x79800000
    v_cmp_nlt_f32 vcc, v10, v12
    v_cmp_u_f32 s[52:53], v11, v11
    v_mov_b32 v12, 0x21800000
    v_cmp_lt_f32 s[54:55], v67, v12
    s_nop 3
    s_or_b64 vcc, vcc, s[52:53]
    s_or_b64 vcc, vcc, s[54:55]
    s_cmp_lg_u32 s50, 0
    s_cbranch_scc1 L_attn_kernel_fin
    s_cbranch_vccz L_attn_kernel_fin
    s_mov_b32 s50, 1
    v_mov_b32 v93, 0
    v_mov_b32 v112, v115
    v_mov_b32 v113, v116
    v_mov_b32 v10, 0xff800000
    s_mov_b32 s51, 0
L_attn_kernel_fl:
    ds_read_b128 v[96:99], v112
    ds_read_b32 v100, v113
    s_waitcnt lgkmcnt(0)
    v_mfma_f32_32x32x16_bf16 v[16:31], v[96:99], v[88:91], 0
    v_mfma_f32_32x32x16_bf16 v[16:31], v[100:103], v[92:95], v[16:31]
    s_nop 7
    s_nop 7
    v_max3_f32 v10, v10, v16, v17
    v_max3_f32 v10, v10, v18, v19
    v_max3_f32 v10, v10, v20, v21
    v_max3_f32 v10, v10, v22, v23
    v_max3_f32 v10, v10, v24, v25
    v_max3_f32 v10, v10, v26, v27
    v_max3_f32 v10, v10, v28, v29
    v_max3_f32 v10, v10, v30, v31
    v_add_u32 v112, 2432, v112
    v_add_u32 v113, 2432, v113
    s_add_u32 s51, s51, 1
    s_cmp_lt_u32 s51, 32
    s_cbranch_scc1 L_attn_kernel_fl
    s_branch L_attn_kernel_run
L_attn_kernel_fin:
    s_barrier
    s_mul_i32 s37, s41, 4096
    v_add_u32 v1, s37, v1
    s_cmp_eq_u32 s40, 0
    s_cbranch_scc1 L_attn_kernel_lo
    v_mov_b32 v66, v72
    ds_write_b128 v1, v[56:59] offset:0
    ds_write_b128 v1, v[60:63] offset:1024
    ds_write_b128 v1, v[64:67] offset:2048
    s_waitcnt lgkmcnt(0)
    s_barrier
    s_endpgm
L_attn_kernel_lo:
    s_barrier
    ds_read_b128 v[16:19], v1 offset:0
    ds_read_b128 v[20:23], v1 offset:1024
    ds_read_b128 v[24:27], v1 offset:2048
    s_waitcnt lgkmcnt(0)
    v_min_f32 v10, v72, v26
    v_sub_f32 v11, v10, v72
    v_sub_f32 v12, v10, v26
    v_exp_f32 v11, v11
    v_exp_f32 v12, v12
    s_nop 0
    v_mul_f32 v56, v11, v56
    v_fmac_f32 v56, v12, v16
    v_mul_f32 v57, v11, v57
    v_fmac_f32 v57, v12, v17
    v_mul_f32 v58, v11, v58
    v_fmac_f32 v58, v12, v18
    v_mul_f32 v59, v11, v59
    v_fmac_f32 v59, v12, v19
    v_mul_f32 v60, v11, v60
    v_fmac_f32 v60, v12, v20
    v_mul_f32 v61, v11, v61
    v_fmac_f32 v61, v12, v21
    v_mul_f32 v62, v11, v62
    v_fmac_f32 v62, v12, v22
    v_mul_f32 v63, v11, v63
    v_fmac_f32 v63, v12, v23
    v_mul_f32 v64, v11, v64
    v_fmac_f32 v64, v12, v24
    v_mul_f32 v65, v11, v65
    v_fmac_f32 v65, v12, v25
    v_mul_f32 v67, v11, v67
    v_fmac_f32 v67, v12, v27
    v_rcp_f32 v10, v67
    s_nop 0
    v_mul_f32 v56, v10, v56
    v_mul_f32 v57, v10, v57
    v_mul_f32 v58, v10, v58
    v_mul_f32 v59, v10, v59
    v_mul_f32 v60, v10, v60
    v_mul_f32 v61, v10, v61
    v_mul_f32 v62, v10, v62
    v_mul_f32 v63, v10, v63
    v_mul_f32 v64, v10, v64
    v_mul_f32 v65, v10, v65
    v_cvt_pk_bf16_f32 v56, v56, v57
    v_cvt_pk_bf16_f32 v57, v58, v59
    v_cvt_pk_bf16_f32 v58, v60, v61
    v_cvt_pk_bf16_f32 v59, v62, v63
    v_cvt_pk_bf16_f32 v60, v64, v65
    s_lshl_b32 s37, s36, 1
    v_lshrrev_b32 v12, 4, v5
    v_add_u32 v12, s37, v12
    v_mul_u32_u24 v12, 18432, v12
    v_and_b32 v13, 15, v5
    v_lshl_add_u32 v12, v13, 4, v12
    v_add_u32 v12, 0x900000, v12
    v_add_u32 v12, s56, v12
    s_lshl_b32 s37, s30, 9
    v_lshl_add_u32 v13, v6, 8, v12
    buffer_store_dwordx4 v[56:59], v13, s[16:19], s37 offen
    s_lshr_b32 s37, s30, 2
    s_lshl_b32 s37, s37, 8
    s_and_b32 s38, s30, 3
    s_lshl_b32 s38, s38, 2
    s_add_u32 s37, s37, s38
    s_add_u32 s37, s37, 16384
    v_lshl_add_u32 v13, v6, 30, v12
    buffer_store_dword v60, v13, s[16:19], s37 offen
L_attn_kernel_end:
    s_endpgm
.globl out_b1_kernel
.p2align 8
.type out_b1_kernel,@function
out_b1_kernel:
    s_mov_b32 s60, 0x0
    s_mov_b32 s61, 0x240000
    s_mov_b32 s62, 0x0
    s_mov_b32 s63, 0x1580000
    s_mov_b32 s59, 0x900000
    s_branch L_outB
.globl out_b2_kernel
.p2align 8
.type out_b2_kernel,@function
out_b2_kernel:
    s_mov_b32 s60, 0x480000
    s_mov_b32 s61, 0x0
    s_mov_b32 s62, 0x1
    s_mov_b32 s63, 0x1580000
    s_mov_b32 s59, 0x900000
    s_branch L_outB
.p2align 8
L_outB:
    s_cmp_ge_u32 s2, 256
    s_cbranch_scc1 L_L_outB_end
    s_load_dwordx2 s[4:5], s[0:1], 64
    v_lshrrev_b32 v4, 6, v0
    s_and_b32 s28, s2, 7
    s_lshr_b32 s29, s2, 3
    v_readfirstlane_b32 s35, v4
    s_and_b32 s30, s29, 7
    s_lshr_b32 s31, s29, 3
    s_lshl_b32 s32, s28, 2
    s_add_u32 s31, s31, s32
    v_and_b32 v3, 63, v0
    v_lshlrev_b32 v15, 4, v3
    s_cmp_lt_u32 s35, 4
    s_cbranch_scc1 L_L_outB_loader
    s_load_dwordx2 s[6:7], s[0:1], 48
    v_and_b32 v5, 15, v3
    v_lshrrev_b32 v6, 4, v3
    s_and_b32 s36, s35, 1
    s_bfe_u32 s37, s35, 0x10001
    s_lshl_b32 s38, s31, 1
    s_add_u32 s38, s38, s36
    s_mul_i32 s40, s38, 36864
    s_mul_i32 s41, s30, 4608
    s_add_u32 s40, s40, s41
    v_and_b32 v11, 1, v6
    v_lshrrev_b32 v7, 1, v6
    v_lshl_add_u32 v12, v11, 1, v7
    s_lshl_b32 s41, s37, 2
    v_add_u32 v12, s41, v12
    v_lshlrev_b32 v13, 9, v12
    v_lshl_add_u32 v13, v5, 4, v13
    v_add_u32 v110, s40, v13
    v_lshlrev_b32 v13, 4, v5
    v_lshl_add_u32 v13, v6, 3, v13
    v_add_u32 v13, s40, v13
    v_add_u32 v13, 4096, v13
    v_cmp_gt_u32 s[48:49], 2, v6
    v_mov_b32 v14, 0x40000000
    s_lshl_b32 s41, s38, 5
    v_cndmask_b32 v111, v14, v13, s[48:49]
    v_add_u32 v13, s41, v5
    v_mul_u32_u24 v13, 1152, v13
    s_mul_i32 s41, s30, 144
    v_add_u32 v13, s41, v13
    v_lshl_add_u32 v8, v12, 4, v13
    v_lshl_add_u32 v13, v6, 3, v13
    v_add_u32 v13, 128, v13
    s_cmp_eq_u32 s62, 1
    s_cselect_b64 vcc, -1, 0
    s_cselect_b32 s43, 0x48, 1
    s_lshl_b32 s43, s43, 8
    v_cndmask_b32 v13, v14, v13, s[48:49]
    v_cndmask_b32 v112, v110, v8, vcc
    v_cndmask_b32 v113, v111, v13, vcc
    s_lshl_b32 s39, s38, 12
    s_lshl_b32 s41, s30, 4
    s_add_u32 s39, s39, s41
    s_lshl_b32 s41, s37, 3
    s_add_u32 s39, s39, s41
    v_lshlrev_b32 v13, 7, v3
    s_cmp_eq_u32 s62, 1
    s_cselect_b32 s41, 0, 2
    v_cmp_gt_u32 vcc, s41, v6
    s_lshl_b32 s41, s37, 11
    v_add_u32 v108, s41, v15
    v_cndmask_b32 v115, v14, v13, vcc
    v_and_b32 v13, 7, v5
    v_lshlrev_b32 v13, 4, v13
    v_lshl_add_u32 v109, v6, 7, v13
    s_mul_i32 s41, s36, 36864
    s_add_u32 s41, s41, 82944
    v_add_u32 v114, s41, v15
    s_waitcnt lgkmcnt(0)
    s_add_u32 s8, s4, s60
    s_addc_u32 s9, s5, 0
    s_mov_b32 s10, 0x240000
    s_mov_b32 s11, 0x00020000
    s_cmp_eq_u32 s62, 1
    s_cselect_b32 s24, s6, s4
    s_cselect_b32 s25, s7, s5
    s_add_u32 s24, s24, s61
    s_addc_u32 s25, s25, 0
    s_mov_b32 s26, 0x240000
    s_mov_b32 s27, 0x00020000
    s_add_u32 s56, s4, s63
    s_addc_u32 s57, s5, 0
    s_mov_b32 s58, 0x40000
    s_mov_b32 s59, 0x00020000
    s_mov_b32 s42, 0x3f803f80
    s_cmp_eq_u32 s37, 1
    s_cbranch_scc1 L_L_outB_ch11
    s_barrier
    ds_read_b128 v[60:63], v108 offset:0
    ds_read_b128 v[52:55], v114 offset:0
    ds_read_b128 v[56:59], v114 offset:18432
    ds_read_b128 v[64:67], v108 offset:1024
    ds_read_b128 v[68:71], v109 offset:8192
    ds_read_b128 v[80:83], v108 offset:4096
    ds_read_b128 v[72:75], v114 offset:1024
    ds_read_b128 v[76:79], v114 offset:19456
    ds_read_b128 v[84:87], v108 offset:5120
    ds_read_b128 v[88:91], v109 offset:8704
    s_waitcnt lgkmcnt(5)
    v_mfma_f32_16x16x32_bf16 v[16:19], v[60:63], v[52:55], 0
    v_mfma_f32_16x16x32_bf16 v[28:31], v[60:63], v[56:59], 0
    v_mfma_f32_16x16x32_bf16 v[20:23], v[64:67], v[52:55], 0
    v_mfma_f32_16x16x32_bf16 v[32:35], v[64:67], v[56:59], 0
    v_mfma_f32_16x16x32_bf16 v[24:27], v[68:71], v[52:55], 0
    v_mfma_f32_16x16x32_bf16 v[36:39], v[68:71], v[56:59], 0
    ds_read_b128 v[60:63], v108 offset:9216
    ds_read_b128 v[52:55], v114 offset:2048
    ds_read_b128 v[56:59], v114 offset:20480
    ds_read_b128 v[64:67], v108 offset:10240
    ds_read_b128 v[68:71], v109 offset:17408
    s_waitcnt lgkmcnt(5)
    v_mfma_f32_16x16x32_bf16 v[16:19], v[80:83], v[72:75], v[16:19]
    v_mfma_f32_16x16x32_bf16 v[28:31], v[80:83], v[76:79], v[28:31]
    v_mfma_f32_16x16x32_bf16 v[20:23], v[84:87], v[72:75], v[20:23]
    v_mfma_f32_16x16x32_bf16 v[32:35], v[84:87], v[76:79], v[32:35]
    v_mfma_f32_16x16x32_bf16 v[24:27], v[88:91], v[72:75], v[24:27]
    v_mfma_f32_16x16x32_bf16 v[36:39], v[88:91], v[76:79], v[36:39]
    ds_read_b128 v[80:83], v108 offset:13312
    ds_read_b128 v[72:75], v114 offset:3072
    ds_read_b128 v[76:79], v114 offset:21504
    ds_read_b128 v[84:87], v108 offset:14336
    ds_read_b128 v[88:91], v109 offset:17920
    s_waitcnt lgkmcnt(5)
    v_mfma_f32_16x16x32_bf16 v[16:19], v[60:63], v[52:55], v[16:19]
    v_mfma_f32_16x16x32_bf16 v[28:31], v[60:63], v[56:59], v[28:31]
    v_mfma_f32_16x16x32_bf16 v[20:23], v[64:67], v[52:55], v[20:23]
    v_mfma_f32_16x16x32_bf16 v[32:35], v[64:67], v[56:59], v[32:35]
    v_mfma_f32_16x16x32_bf16 v[24:27], v[68:71], v[52:55], v[24:27]
    v_mfma_f32_16x16x32_bf16 v[36:39], v[68:71], v[56:59], v[36:39]
    s_waitcnt lgkmcnt(0)
    v_mfma_f32_16x16x32_bf16 v[16:19], v[80:83], v[72:75], v[16:19]
    v_mfma_f32_16x16x32_bf16 v[28:31], v[80:83], v[76:79], v[28:31]
    v_mfma_f32_16x16x32_bf16 v[20:23], v[84:87], v[72:75], v[20:23]
    v_mfma_f32_16x16x32_bf16 v[32:35], v[84:87], v[76:79], v[32:35]
    v_mfma_f32_16x16x32_bf16 v[24:27], v[88:91], v[72:75], v[24:27]
    v_mfma_f32_16x16x32_bf16 v[36:39], v[88:91], v[76:79], v[36:39]
    s_barrier
    ds_read_b128 v[60:63], v108 offset:18432
    ds_read_b128 v[52:55], v114 offset:4096
    ds_read_b128 v[56:59], v114 offset:22528
    ds_read_b128 v[64:67], v108 offset:19456
    ds_read_b128 v[68:71], v109 offset:26624
    ds_read_b128 v[80:83], v108 offset:22528
    ds_read_b128 v[72:75], v114 offset:5120
    ds_read_b128 v[76:79], v114 offset:23552
    ds_read_b128 v[84:87], v108 offset:23552
    ds_read_b128 v[88:91], v109 offset:27136
    s_waitcnt lgkmcnt(5)
    v_mfma_f32_16x16x32_bf16 v[16:19], v[60:63], v[52:55], v[16:19]
    v_mfma_f32_16x16x32_bf16 v[28:31], v[60:63], v[56:59], v[28:31]
    v_mfma_f32_16x16x32_bf16 v[20:23], v[64:67], v[52:55], v[20:23]
    v_mfma_f32_16x16x32_bf16 v[32:35], v[64:67], v[56:59], v[32:35]
    v_mfma_f32_16x16x32_bf16 v[24:27], v[68:71], v[52:55], v[24:27]
    v_mfma_f32_16x16x32_bf16 v[36:39], v[68:71], v[56:59], v[36:39]
    ds_read_b128 v[60:63], v108 offset:27648
    ds_read_b128 v[52:55], v114 offset:6144
    ds_read_b128 v[56:59], v114 offset:24576
    ds_read_b128 v[64:67], v108 offset:28672
    ds_read_b128 v[68:71], v109 offset:35840
    s_waitcnt lgkmcnt(5)
    v_mfma_f32_16x16x32_bf16 v[16:19], v[80:83], v[72:75], v[16:19]
    v_mfma_f32_16x16x32_bf16 v[28:31], v[80:83], v[76:79], v[28:31]
    v_mfma_f32_16x16x32_bf16 v[20:23], v[84:87], v[72:75], v[20:23]
    v_mfma_f32_16x16x32_bf16 v[32:35], v[84:87], v[76:79], v[32:35]
    v_mfma_f32_16x16x32_bf16 v[24:27], v[88:91], v[72:75], v[24:27]
    v_mfma_f32_16x16x32_bf16 v[36:39], v[88:91], v[76:79], v[36:39]
    ds_read_b128 v[80:83], v108 offset:31744
    ds_read_b128 v[72:75], v114 offset:7168
    ds_read_b128 v[76:79], v114 offset:25600
    ds_read_b128 v[84:87], v108 offset:32768
    ds_read_b128 v[88:91], v109 offset:36352
    s_waitcnt lgkmcnt(5)
    v_mfma_f32_16x16x32_bf16 v[16:19], v[60:63], v[52:55], v[16:19]
    v_mfma_f32_16x16x32_bf16 v[28:31], v[60:63], v[56:59], v[28:31]
    v_mfma_f32_16x16x32_bf16 v[20:23], v[64:67], v[52:55], v[20:23]
    v_mfma_f32_16x16x32_bf16 v[32:35], v[64:67], v[56:59], v[32:35]
    v_mfma_f32_16x16x32_bf16 v[24:27], v[68:71], v[52:55], v[24:27]
    v_mfma_f32_16x16x32_bf16 v[36:39], v[68:71], v[56:59], v[36:39]
    s_waitcnt lgkmcnt(0)
    v_mfma_f32_16x16x32_bf16 v[16:19], v[80:83], v[72:75], v[16:19]
    v_mfma_f32_16x16x32_bf16 v[28:31], v[80:83], v[76:79], v[28:31]
    v_mfma_f32_16x16x32_bf16 v[20:23], v[84:87], v[72:75], v[20:23]
    v_mfma_f32_16x16x32_bf16 v[32:35], v[84:87], v[76:79], v[32:35]
    v_mfma_f32_16x16x32_bf16 v[24:27], v[88:91], v[72:75], v[24:27]
    v_mfma_f32_16x16x32_bf16 v[36:39], v[88:91], v[76:79], v[36:39]
    buffer_load_dwordx4 v[40:43], v110, s[8:11], 0 offen offset:0
    buffer_load_dwordx2 v[44:45], v111, s[8:11], 0 offen offset:0
    buffer_load_dwordx4 v[46:49], v110, s[8:11], 0 offen offset:256
    buffer_load_dwordx2 v[50:51], v111, s[8:11], 0 offen offset:256
    s_barrier
    ds_read_b128 v[60:63], v108 offset:36864
    ds_read_b128 v[52:55], v114 offset:8192
    ds_read_b128 v[56:59], v114 offset:26624
    ds_read_b128 v[64:67], v108 offset:37888
    ds_read_b128 v[68:71], v109 offset:45056
    ds_read_b128 v[80:83], v108 offset:40960
    ds_read_b128 v[72:75], v114 offset:9216
    ds_read_b128 v[76:79], v114 offset:27648
    ds_read_b128 v[84:87], v108 offset:41984
    ds_read_b128 v[88:91], v109 offset:45568
    s_waitcnt lgkmcnt(5)
    v_mfma_f32_16x16x32_bf16 v[16:19], v[60:63], v[52:55], v[16:19]
    v_mfma_f32_16x16x32_bf16 v[28:31], v[60:63], v[56:59], v[28:31]
    v_mfma_f32_16x16x32_bf16 v[20:23], v[64:67], v[52:55], v[20:23]
    v_mfma_f32_16x16x32_bf16 v[32:35], v[64:67], v[56:59], v[32:35]
    v_mfma_f32_16x16x32_bf16 v[24:27], v[68:71], v[52:55], v[24:27]
    v_mfma_f32_16x16x32_bf16 v[36:39], v[68:71], v[56:59], v[36:39]
    v_add_u32 v108, 46080, v108
    v_add_u32 v109, 46080, v109
    ds_read_b128 v[60:63], v108 offset:0
    ds_read_b128 v[52:55], v114 offset:10240
    ds_read_b128 v[56:59], v114 offset:28672
    ds_read_b128 v[64:67], v108 offset:1024
    ds_read_b128 v[68:71], v109 offset:8192
    s_waitcnt lgkmcnt(5)
    v_mfma_f32_16x16x32_bf16 v[16:19], v[80:83], v[72:75], v[16:19]
    v_mfma_f32_16x16x32_bf16 v[28:31], v[80:83], v[76:79], v[28:31]
    v_mfma_f32_16x16x32_bf16 v[20:23], v[84:87], v[72:75], v[20:23]
    v_mfma_f32_16x16x32_bf16 v[32:35], v[84:87], v[76:79], v[32:35]
    v_mfma_f32_16x16x32_bf16 v[24:27], v[88:91], v[72:75], v[24:27]
    v_mfma_f32_16x16x32_bf16 v[36:39], v[88:91], v[76:79], v[36:39]
    ds_read_b128 v[80:83], v108 offset:4096
    ds_read_b128 v[72:75], v114 offset:11264
    ds_read_b128 v[76:79], v114 offset:29696
    ds_read_b128 v[84:87], v108 offset:5120
    ds_read_b128 v[88:91], v109 offset:8704
    s_waitcnt lgkmcnt(5)
    v_mfma_f32_16x16x32_bf16 v[16:19], v[60:63], v[52:55], v[16:19]
    v_mfma_f32_16x16x32_bf16 v[28:31], v[60:63], v[56:59], v[28:31]
    v_mfma_f32_16x16x32_bf16 v[20:23], v[64:67], v[52:55], v[20:23]
    v_mfma_f32_16x16x32_bf16 v[32:35], v[64:67], v[56:59], v[32:35]
    v_mfma_f32_16x16x32_bf16 v[24:27], v[68:71], v[52:55], v[24:27]
    v_mfma_f32_16x16x32_bf16 v[36:39], v[68:71], v[56:59], v[36:39]
    s_waitcnt lgkmcnt(0)
    v_mfma_f32_16x16x32_bf16 v[16:19], v[80:83], v[72:75], v[16:19]
    v_mfma_f32_16x16x32_bf16 v[28:31], v[80:83], v[76:79], v[28:31]
    v_mfma_f32_16x16x32_bf16 v[20:23], v[84:87], v[72:75], v[20:23]
    v_mfma_f32_16x16x32_bf16 v[32:35], v[84:87], v[76:79], v[32:35]
    v_mfma_f32_16x16x32_bf16 v[24:27], v[88:91], v[72:75], v[24:27]
    v_mfma_f32_16x16x32_bf16 v[36:39], v[88:91], v[76:79], v[36:39]
    s_barrier
    ds_read_b128 v[60:63], v108 offset:9216
    ds_read_b128 v[52:55], v114 offset:12288
    ds_read_b128 v[56:59], v114 offset:30720
    ds_read_b128 v[64:67], v108 offset:10240
    ds_read_b128 v[68:71], v109 offset:17408
    ds_read_b128 v[80:83], v108 offset:13312
    ds_read_b128 v[72:75], v114 offset:13312
    ds_read_b128 v[76:79], v114 offset:31744
    ds_read_b128 v[84:87], v108 offset:14336
    ds_read_b128 v[88:91], v109 offset:17920
    s_waitcnt lgkmcnt(5)
    v_mfma_f32_16x16x32_bf16 v[16:19], v[60:63], v[52:55], v[16:19]
    v_mfma_f32_16x16x32_bf16 v[28:31], v[60:63], v[56:59], v[28:31]
    v_mfma_f32_16x16x32_bf16 v[20:23], v[64:67], v[52:55], v[20:23]
    v_mfma_f32_16x16x32_bf16 v[32:35], v[64:67], v[56:59], v[32:35]
    v_mfma_f32_16x16x32_bf16 v[24:27], v[68:71], v[52:55], v[24:27]
    v_mfma_f32_16x16x32_bf16 v[36:39], v[68:71], v[56:59], v[36:39]
    s_waitcnt lgkmcnt(0)
    v_mfma_f32_16x16x32_bf16 v[16:19], v[80:83], v[72:75], v[16:19]
    v_mfma_f32_16x16x32_bf16 v[28:31], v[80:83], v[76:79], v[28:31]
    v_mfma_f32_16x16x32_bf16 v[20:23], v[84:87], v[72:75], v[20:23]
    v_mfma_f32_16x16x32_bf16 v[32:35], v[84:87], v[76:79], v[32:35]
    v_mfma_f32_16x16x32_bf16 v[24:27], v[88:91], v[72:75], v[24:27]
    v_mfma_f32_16x16x32_bf16 v[36:39], v[88:91], v[76:79], v[36:39]
    s_barrier
    ds_read_b128 v[60:63], v108 offset:18432
    ds_read_b128 v[52:55], v114 offset:14336
    ds_read_b128 v[56:59], v114 offset:32768
    ds_read_b128 v[64:67], v108 offset:19456
    ds_read_b128 v[68:71], v109 offset:26624
    ds_read_b128 v[80:83], v108 offset:22528
    ds_read_b128 v[72:75], v114 offset:15360
    ds_read_b128 v[76:79], v114 offset:33792
    ds_read_b128 v[84:87], v108 offset:23552
    ds_read_b128 v[88:91], v109 offset:27136
    s_waitcnt lgkmcnt(5)
    v_mfma_f32_16x16x32_bf16 v[16:19], v[60:63], v[52:55], v[16:19]
    v_mfma_f32_16x16x32_bf16 v[28:31], v[60:63], v[56:59], v[28:31]
    v_mfma_f32_16x16x32_bf16 v[20:23], v[64:67], v[52:55], v[20:23]
    v_mfma_f32_16x16x32_bf16 v[32:35], v[64:67], v[56:59], v[32:35]
    v_mfma_f32_16x16x32_bf16 v[24:27], v[68:71], v[52:55], v[24:27]
    v_mfma_f32_16x16x32_bf16 v[36:39], v[68:71], v[56:59], v[36:39]
    s_waitcnt lgkmcnt(0)
    v_mfma_f32_16x16x32_bf16 v[16:19], v[80:83], v[72:75], v[16:19]
    v_mfma_f32_16x16x32_bf16 v[28:31], v[80:83], v[76:79], v[28:31]
    v_mfma_f32_16x16x32_bf16 v[20:23], v[84:87], v[72:75], v[20:23]
    v_mfma_f32_16x16x32_bf16 v[32:35], v[84:87], v[76:79], v[32:35]
    v_mfma_f32_16x16x32_bf16 v[24:27], v[88:91], v[72:75], v[24:27]
    v_mfma_f32_16x16x32_bf16 v[36:39], v[88:91], v[76:79], v[36:39]
    s_waitcnt vmcnt(0)
    v_lshlrev_b32 v92, 16, v40
    v_and_b32 v93, 0xffff0000, v40
    v_lshlrev_b32 v94, 16, v41
    v_and_b32 v95, 0xffff0000, v41
    v_lshlrev_b32 v96, 16, v42
    v_and_b32 v97, 0xffff0000, v42
    v_lshlrev_b32 v98, 16, v43
    v_and_b32 v99, 0xffff0000, v43
    v_lshlrev_b32 v100, 16, v44
    v_and_b32 v101, 0xffff0000, v44
    v_lshlrev_b32 v102, 16, v45
    v_and_b32 v103, 0xffff0000, v45
    s_barrier
    ds_read_b128 v[60:63], v108 offset:27648
    ds_read_b128 v[52:55], v114 offset:16384
    ds_read_b128 v[56:59], v114 offset:34816
    ds_read_b128 v[64:67], v108 offset:28672
    ds_read_b128 v[68:71], v109 offset:35840
    ds_read_b128 v[80:83], v108 offset:31744
    ds_read_b128 v[72:75], v114 offset:17408
    ds_read_b128 v[76:79], v114 offset:35840
    ds_read_b128 v[84:87], v108 offset:32768
    ds_read_b128 v[88:91], v109 offset:36352
    s_waitcnt lgkmcnt(5)
    v_mfma_f32_16x16x32_bf16 v[16:19], v[60:63], v[52:55], v[16:19]
    v_mfma_f32_16x16x32_bf16 v[28:31], v[60:63], v[56:59], v[28:31]
    v_mfma_f32_16x16x32_bf16 v[20:23], v[64:67], v[52:55], v[20:23]
    v_mfma_f32_16x16x32_bf16 v[32:35], v[64:67], v[56:59], v[32:35]
    v_mfma_f32_16x16x32_bf16 v[24:27], v[68:71], v[52:55], v[24:27]
    v_mfma_f32_16x16x32_bf16 v[36:39], v[68:71], v[56:59], v[36:39]
    s_waitcnt lgkmcnt(0)
    v_mfma_f32_16x16x32_bf16 v[16:19], v[80:83], v[72:75], v[16:19]
    v_mfma_f32_16x16x32_bf16 v[28:31], v[80:83], v[76:79], v[28:31]
    v_mfma_f32_16x16x32_bf16 v[20:23], v[84:87], v[72:75], v[20:23]
    v_mfma_f32_16x16x32_bf16 v[32:35], v[84:87], v[76:79], v[32:35]
    v_mfma_f32_16x16x32_bf16 v[24:27], v[88:91], v[72:75], v[24:27]
    v_mfma_f32_16x16x32_bf16 v[36:39], v[88:91], v[76:79], v[36:39]
    v_lshlrev_b32 v52, 16, v46
    v_and_b32 v53, 0xffff0000, v46
    v_lshlrev_b32 v54, 16, v47
    v_and_b32 v55, 0xffff0000, v47
    v_lshlrev_b32 v56, 16, v48
    v_and_b32 v57, 0xffff0000, v48
    v_lshlrev_b32 v58, 16, v49
    v_and_b32 v59, 0xffff0000, v49
    v_lshlrev_b32 v60, 16, v50
    v_and_b32 v61, 0xffff0000, v50
    v_lshlrev_b32 v62, 16, v51
    v_and_b32 v63, 0xffff0000, v51
    v_mov_b32 v8, 0
    v_mov_b32 v9, 0
    v_mov_b32 v10, 0
    v_mov_b32 v11, 0
    v_permlane16_swap_b32 v16, v20
    v_permlane16_swap_b32 v17, v21
    v_permlane16_swap_b32 v18, v22
    v_permlane16_swap_b32 v19, v23
    v_pk_add_f32 v[24:25], v[24:25], v[100:101]
    v_pk_add_f32 v[26:27], v[26:27], v[102:103]
    v_pk_add_f32 v[16:17], v[16:17], v[92:93]
    v_pk_add_f32 v[18:19], v[18:19], v[94:95]
    v_pk_add_f32 v[20:21], v[20:21], v[96:97]
    v_pk_add_f32 v[22:23], v[22:23], v[98:99]
    v_cvt_pk_bf16_f32 v72, v16, v17
    v_cvt_pk_bf16_f32 v73, v18, v19
    v_cvt_pk_bf16_f32 v74, v20, v21
    v_cvt_pk_bf16_f32 v75, v22, v23
    v_cvt_pk_bf16_f32 v76, v24, v25
    v_cvt_pk_bf16_f32 v77, v26, v27
    buffer_store_dwordx4 v[72:75], v112, s[24:27], 0 offen
    buffer_store_dwordx2 v[76:77], v113, s[24:27], 0 offen
    v_cndmask_b32 v78, 0, v76, s[48:49]
    v_cndmask_b32 v79, 0, v77, s[48:49]
    v_permlane16_swap_b32 v28, v32
    v_permlane16_swap_b32 v29, v33
    v_permlane16_swap_b32 v30, v34
    v_permlane16_swap_b32 v31, v35
    v_pk_add_f32 v[36:37], v[36:37], v[60:61]
    v_pk_add_f32 v[38:39], v[38:39], v[62:63]
    v_pk_add_f32 v[28:29], v[28:29], v[52:53]
    v_pk_add_f32 v[30:31], v[30:31], v[54:55]
    v_pk_add_f32 v[32:33], v[32:33], v[56:57]
    v_pk_add_f32 v[34:35], v[34:35], v[58:59]
    v_cvt_pk_bf16_f32 v80, v28, v29
    v_cvt_pk_bf16_f32 v81, v30, v31
    v_cvt_pk_bf16_f32 v82, v32, v33
    v_cvt_pk_bf16_f32 v83, v34, v35
    v_cvt_pk_bf16_f32 v84, v36, v37
    v_cvt_pk_bf16_f32 v85, v38, v39
    buffer_store_dwordx4 v[80:83], v112, s[24:27], s43 offen
    buffer_store_dwordx2 v[84:85], v113, s[24:27], s43 offen
    v_cndmask_b32 v86, 0, v84, s[48:49]
    v_cndmask_b32 v87, 0, v85, s[48:49]
    v_dot2_f32_bf16 v8, v72, s42, v8
    v_dot2_f32_bf16 v9, v72, v72, v9
    v_dot2_f32_bf16 v10, v80, s42, v10
    v_dot2_f32_bf16 v11, v80, v80, v11
    v_dot2_f32_bf16 v8, v73, s42, v8
    v_dot2_f32_bf16 v9, v73, v73, v9
    v_dot2_f32_bf16 v10, v81, s42, v10
    v_dot2_f32_bf16 v11, v81, v81, v11
    v_dot2_f32_bf16 v8, v74, s42, v8
    v_dot2_f32_bf16 v9, v74, v74, v9
    v_dot2_f32_bf16 v10, v82, s42, v10
    v_dot2_f32_bf16 v11, v82, v82, v11
    v_dot2_f32_bf16 v8, v75, s42, v8
    v_dot2_f32_bf16 v9, v75, v75, v9
    v_dot2_f32_bf16 v10, v83, s42, v10
    v_dot2_f32_bf16 v11, v83, v83, v11
    v_dot2_f32_bf16 v8, v78, s42, v8
    v_dot2_f32_bf16 v9, v78, v78, v9
    v_dot2_f32_bf16 v10, v86, s42, v10
    v_dot2_f32_bf16 v11, v86, v86, v11
    v_dot2_f32_bf16 v8, v79, s42, v8
    v_dot2_f32_bf16 v9, v79, v79, v9
    v_dot2_f32_bf16 v10, v87, s42, v10
    v_dot2_f32_bf16 v11, v87, v87, v11
    s_nop 2
    v_permlane16_swap_b32 v8, v10
    v_permlane16_swap_b32 v9, v11
    s_nop 1
    v_pk_add_f32 v[8:9], v[8:9], v[10:11]
    s_nop 0
    v_mov_b32 v10, v8
    v_mov_b32 v11, v9
    s_nop 1
    v_permlane32_swap_b32 v10, v8
    v_permlane32_swap_b32 v11, v9
    s_nop 1
    v_pk_add_f32 v[8:9], v[8:9], v[10:11]
    buffer_store_dwordx2 v[8:9], v115, s[56:59], s39 offen
    s_endpgm
L_L_outB_ch11:
    s_barrier
    ds_read_b128 v[60:63], v108 offset:0
    ds_read_b128 v[52:55], v114 offset:0
    ds_read_b128 v[56:59], v114 offset:18432
    ds_read_b128 v[64:67], v108 offset:1024
    ds_read_b128 v[80:83], v108 offset:4096
    ds_read_b128 v[72:75], v114 offset:1024
    ds_read_b128 v[76:79], v114 offset:19456
    ds_read_b128 v[84:87], v108 offset:5120
    s_waitcnt lgkmcnt(4)
    v_mfma_f32_16x16x32_bf16 v[16:19], v[60:63], v[52:55], 0
    v_mfma_f32_16x16x32_bf16 v[28:31], v[60:63], v[56:59], 0
    v_mfma_f32_16x16x32_bf16 v[20:23], v[64:67], v[52:55], 0
    v_mfma_f32_16x16x32_bf16 v[32:35], v[64:67], v[56:59], 0
    ds_read_b128 v[60:63], v108 offset:9216
    ds_read_b128 v[52:55], v114 offset:2048
    ds_read_b128 v[56:59], v114 offset:20480
    ds_read_b128 v[64:67], v108 offset:10240
    s_waitcnt lgkmcnt(4)
    v_mfma_f32_16x16x32_bf16 v[16:19], v[80:83], v[72:75], v[16:19]
    v_mfma_f32_16x16x32_bf16 v[28:31], v[80:83], v[76:79], v[28:31]
    v_mfma_f32_16x16x32_bf16 v[20:23], v[84:87], v[72:75], v[20:23]
    v_mfma_f32_16x16x32_bf16 v[32:35], v[84:87], v[76:79], v[32:35]
    ds_read_b128 v[80:83], v108 offset:13312
    ds_read_b128 v[72:75], v114 offset:3072
    ds_read_b128 v[76:79], v114 offset:21504
    ds_read_b128 v[84:87], v108 offset:14336
    s_waitcnt lgkmcnt(4)
    v_mfma_f32_16x16x32_bf16 v[16:19], v[60:63], v[52:55], v[16:19]
    v_mfma_f32_16x16x32_bf16 v[28:31], v[60:63], v[56:59], v[28:31]
    v_mfma_f32_16x16x32_bf16 v[20:23], v[64:67], v[52:55], v[20:23]
    v_mfma_f32_16x16x32_bf16 v[32:35], v[64:67], v[56:59], v[32:35]
    s_waitcnt lgkmcnt(0)
    v_mfma_f32_16x16x32_bf16 v[16:19], v[80:83], v[72:75], v[16:19]
    v_mfma_f32_16x16x32_bf16 v[28:31], v[80:83], v[76:79], v[28:31]
    v_mfma_f32_16x16x32_bf16 v[20:23], v[84:87], v[72:75], v[20:23]
    v_mfma_f32_16x16x32_bf16 v[32:35], v[84:87], v[76:79], v[32:35]
    s_barrier
    ds_read_b128 v[60:63], v108 offset:18432
    ds_read_b128 v[52:55], v114 offset:4096
    ds_read_b128 v[56:59], v114 offset:22528
    ds_read_b128 v[64:67], v108 offset:19456
    ds_read_b128 v[80:83], v108 offset:22528
    ds_read_b128 v[72:75], v114 offset:5120
    ds_read_b128 v[76:79], v114 offset:23552
    ds_read_b128 v[84:87], v108 offset:23552
    s_waitcnt lgkmcnt(4)
    v_mfma_f32_16x16x32_bf16 v[16:19], v[60:63], v[52:55], v[16:19]
    v_mfma_f32_16x16x32_bf16 v[28:31], v[60:63], v[56:59], v[28:31]
    v_mfma_f32_16x16x32_bf16 v[20:23], v[64:67], v[52:55], v[20:23]
    v_mfma_f32_16x16x32_bf16 v[32:35], v[64:67], v[56:59], v[32:35]
    ds_read_b128 v[60:63], v108 offset:27648
    ds_read_b128 v[52:55], v114 offset:6144
    ds_read_b128 v[56:59], v114 offset:24576
    ds_read_b128 v[64:67], v108 offset:28672
    s_waitcnt lgkmcnt(4)
    v_mfma_f32_16x16x32_bf16 v[16:19], v[80:83], v[72:75], v[16:19]
    v_mfma_f32_16x16x32_bf16 v[28:31], v[80:83], v[76:79], v[28:31]
    v_mfma_f32_16x16x32_bf16 v[20:23], v[84:87], v[72:75], v[20:23]
    v_mfma_f32_16x16x32_bf16 v[32:35], v[84:87], v[76:79], v[32:35]
    ds_read_b128 v[80:83], v108 offset:31744
    ds_read_b128 v[72:75], v114 offset:7168
    ds_read_b128 v[76:79], v114 offset:25600
    ds_read_b128 v[84:87], v108 offset:32768
    s_waitcnt lgkmcnt(4)
    v_mfma_f32_16x16x32_bf16 v[16:19], v[60:63], v[52:55], v[16:19]
    v_mfma_f32_16x16x32_bf16 v[28:31], v[60:63], v[56:59], v[28:31]
    v_mfma_f32_16x16x32_bf16 v[20:23], v[64:67], v[52:55], v[20:23]
    v_mfma_f32_16x16x32_bf16 v[32:35], v[64:67], v[56:59], v[32:35]
    s_waitcnt lgkmcnt(0)
    v_mfma_f32_16x16x32_bf16 v[16:19], v[80:83], v[72:75], v[16:19]
    v_mfma_f32_16x16x32_bf16 v[28:31], v[80:83], v[76:79], v[28:31]
    v_mfma_f32_16x16x32_bf16 v[20:23], v[84:87], v[72:75], v[20:23]
    v_mfma_f32_16x16x32_bf16 v[32:35], v[84:87], v[76:79], v[32:35]
    buffer_load_dwordx4 v[40:43], v110, s[8:11], 0 offen offset:0
    buffer_load_dwordx4 v[46:49], v110, s[8:11], 0 offen offset:256
    s_barrier
    ds_read_b128 v[60:63], v108 offset:36864
    ds_read_b128 v[52:55], v114 offset:8192
    ds_read_b128 v[56:59], v114 offset:26624
    ds_read_b128 v[64:67], v108 offset:37888
    ds_read_b128 v[80:83], v108 offset:40960
    ds_read_b128 v[72:75], v114 offset:9216
    ds_read_b128 v[76:79], v114 offset:27648
    ds_read_b128 v[84:87], v108 offset:41984
    s_waitcnt lgkmcnt(4)
    v_mfma_f32_16x16x32_bf16 v[16:19], v[60:63], v[52:55], v[16:19]
    v_mfma_f32_16x16x32_bf16 v[28:31], v[60:63], v[56:59], v[28:31]
    v_mfma_f32_16x16x32_bf16 v[20:23], v[64:67], v[52:55], v[20:23]
    v_mfma_f32_16x16x32_bf16 v[32:35], v[64:67], v[56:59], v[32:35]
    v_add_u32 v108, 46080, v108
    v_add_u32 v109, 46080, v109
    ds_read_b128 v[60:63], v108 offset:0
    ds_read_b128 v[52:55], v114 offset:10240
    ds_read_b128 v[56:59], v114 offset:28672
    ds_read_b128 v[64:67], v108 offset:1024
    s_waitcnt lgkmcnt(4)
    v_mfma_f32_16x16x32_bf16 v[16:19], v[80:83], v[72:75], v[16:19]
    v_mfma_f32_16x16x32_bf16 v[28:31], v[80:83], v[76:79], v[28:31]
    v_mfma_f32_16x16x32_bf16 v[20:23], v[84:87], v[72:75], v[20:23]
    v_mfma_f32_16x16x32_bf16 v[32:35], v[84:87], v[76:79], v[32:35]
    ds_read_b128 v[80:83], v108 offset:4096
    ds_read_b128 v[72:75], v114 offset:11264
    ds_read_b128 v[76:79], v114 offset:29696
    ds_read_b128 v[84:87], v108 offset:5120
    s_waitcnt lgkmcnt(4)
    v_mfma_f32_16x16x32_bf16 v[16:19], v[60:63], v[52:55], v[16:19]
    v_mfma_f32_16x16x32_bf16 v[28:31], v[60:63], v[56:59], v[28:31]
    v_mfma_f32_16x16x32_bf16 v[20:23], v[64:67], v[52:55], v[20:23]
    v_mfma_f32_16x16x32_bf16 v[32:35], v[64:67], v[56:59], v[32:35]
    s_waitcnt lgkmcnt(0)
    v_mfma_f32_16x16x32_bf16 v[16:19], v[80:83], v[72:75], v[16:19]
    v_mfma_f32_16x16x32_bf16 v[28:31], v[80:83], v[76:79], v[28:31]
    v_mfma_f32_16x16x32_bf16 v[20:23], v[84:87], v[72:75], v[20:23]
    v_mfma_f32_16x16x32_bf16 v[32:35], v[84:87], v[76:79], v[32:35]
    s_barrier
    ds_read_b128 v[60:63], v108 offset:9216
    ds_read_b128 v[52:55], v114 offset:12288
    ds_read_b128 v[56:59], v114 offset:30720
    ds_read_b128 v[64:67], v108 offset:10240
    ds_read_b128 v[80:83], v108 offset:13312
    ds_read_b128 v[72:75], v114 offset:13312
    ds_read_b128 v[76:79], v114 offset:31744
    ds_read_b128 v[84:87], v108 offset:14336
    s_waitcnt lgkmcnt(4)
    v_mfma_f32_16x16x32_bf16 v[16:19], v[60:63], v[52:55], v[16:19]
    v_mfma_f32_16x16x32_bf16 v[28:31], v[60:63], v[56:59], v[28:31]
    v_mfma_f32_16x16x32_bf16 v[20:23], v[64:67], v[52:55], v[20:23]
    v_mfma_f32_16x16x32_bf16 v[32:35], v[64:67], v[56:59], v[32:35]
    s_waitcnt lgkmcnt(0)
    v_mfma_f32_16x16x32_bf16 v[16:19], v[80:83], v[72:75], v[16:19]
    v_mfma_f32_16x16x32_bf16 v[28:31], v[80:83], v[76:79], v[28:31]
    v_mfma_f32_16x16x32_bf16 v[20:23], v[84:87], v[72:75], v[20:23]
    v_mfma_f32_16x16x32_bf16 v[32:35], v[84:87], v[76:79], v[32:35]
    s_barrier
    ds_read_b128 v[60:63], v108 offset:18432
    ds_read_b128 v[52:55], v114 offset:14336
    ds_read_b128 v[56:59], v114 offset:32768
    ds_read_b128 v[64:67], v108 offset:19456
    ds_read_b128 v[80:83], v108 offset:22528
    ds_read_b128 v[72:75], v114 offset:15360
    ds_read_b128 v[76:79], v114 offset:33792
    ds_read_b128 v[84:87], v108 offset:23552
    s_waitcnt lgkmcnt(4)
    v_mfma_f32_16x16x32_bf16 v[16:19], v[60:63], v[52:55], v[16:19]
    v_mfma_f32_16x16x32_bf16 v[28:31], v[60:63], v[56:59], v[28:31]
    v_mfma_f32_16x16x32_bf16 v[20:23], v[64:67], v[52:55], v[20:23]
    v_mfma_f32_16x16x32_bf16 v[32:35], v[64:67], v[56:59], v[32:35]
    s_waitcnt lgkmcnt(0)
    v_mfma_f32_16x16x32_bf16 v[16:19], v[80:83], v[72:75], v[16:19]
    v_mfma_f32_16x16x32_bf16 v[28:31], v[80:83], v[76:79], v[28:31]
    v_mfma_f32_16x16x32_bf16 v[20:23], v[84:87], v[72:75], v[20:23]
    v_mfma_f32_16x16x32_bf16 v[32:35], v[84:87], v[76:79], v[32:35]
    s_waitcnt vmcnt(0)
    v_lshlrev_b32 v92, 16, v40
    v_and_b32 v93, 0xffff0000, v40
    v_lshlrev_b32 v94, 16, v41
    v_and_b32 v95, 0xffff0000, v41
    v_lshlrev_b32 v96, 16, v42
    v_and_b32 v97, 0xffff0000, v42
    v_lshlrev_b32 v98, 16, v43
    v_and_b32 v99, 0xffff0000, v43
    s_barrier
    ds_read_b128 v[60:63], v108 offset:27648
    ds_read_b128 v[52:55], v114 offset:16384
    ds_read_b128 v[56:59], v114 offset:34816
    ds_read_b128 v[64:67], v108 offset:28672
    ds_read_b128 v[80:83], v108 offset:31744
    ds_read_b128 v[72:75], v114 offset:17408
    ds_read_b128 v[76:79], v114 offset:35840
    ds_read_b128 v[84:87], v108 offset:32768
    s_waitcnt lgkmcnt(4)
    v_mfma_f32_16x16x32_bf16 v[16:19], v[60:63], v[52:55], v[16:19]
    v_mfma_f32_16x16x32_bf16 v[28:31], v[60:63], v[56:59], v[28:31]
    v_mfma_f32_16x16x32_bf16 v[20:23], v[64:67], v[52:55], v[20:23]
    v_mfma_f32_16x16x32_bf16 v[32:35], v[64:67], v[56:59], v[32:35]
    s_waitcnt lgkmcnt(0)
    v_mfma_f32_16x16x32_bf16 v[16:19], v[80:83], v[72:75], v[16:19]
    v_mfma_f32_16x16x32_bf16 v[28:31], v[80:83], v[76:79], v[28:31]
    v_mfma_f32_16x16x32_bf16 v[20:23], v[84:87], v[72:75], v[20:23]
    v_mfma_f32_16x16x32_bf16 v[32:35], v[84:87], v[76:79], v[32:35]
    v_lshlrev_b32 v52, 16, v46
    v_and_b32 v53, 0xffff0000, v46
    v_lshlrev_b32 v54, 16, v47
    v_and_b32 v55, 0xffff0000, v47
    v_lshlrev_b32 v56, 16, v48
    v_and_b32 v57, 0xffff0000, v48
    v_lshlrev_b32 v58, 16, v49
    v_and_b32 v59, 0xffff0000, v49
    v_mov_b32 v8, 0
    v_mov_b32 v9, 0
    v_mov_b32 v10, 0
    v_mov_b32 v11, 0
    v_permlane16_swap_b32 v16, v20
    v_permlane16_swap_b32 v17, v21
    v_permlane16_swap_b32 v18, v22
    v_permlane16_swap_b32 v19, v23
    s_nop 1
    v_pk_add_f32 v[16:17], v[16:17], v[92:93]
    v_pk_add_f32 v[18:19], v[18:19], v[94:95]
    v_pk_add_f32 v[20:21], v[20:21], v[96:97]
    v_pk_add_f32 v[22:23], v[22:23], v[98:99]
    v_cvt_pk_bf16_f32 v72, v16, v17
    v_cvt_pk_bf16_f32 v73, v18, v19
    v_cvt_pk_bf16_f32 v74, v20, v21
    v_cvt_pk_bf16_f32 v75, v22, v23
    buffer_store_dwordx4 v[72:75], v112, s[24:27], 0 offen
    v_permlane16_swap_b32 v28, v32
    v_permlane16_swap_b32 v29, v33
    v_permlane16_swap_b32 v30, v34
    v_permlane16_swap_b32 v31, v35
    s_nop 1
    v_pk_add_f32 v[28:29], v[28:29], v[52:53]
    v_pk_add_f32 v[30:31], v[30:31], v[54:55]
    v_pk_add_f32 v[32:33], v[32:33], v[56:57]
    v_pk_add_f32 v[34:35], v[34:35], v[58:59]
    v_cvt_pk_bf16_f32 v80, v28, v29
    v_cvt_pk_bf16_f32 v81, v30, v31
    v_cvt_pk_bf16_f32 v82, v32, v33
    v_cvt_pk_bf16_f32 v83, v34, v35
    buffer_store_dwordx4 v[80:83], v112, s[24:27], s43 offen
    v_dot2_f32_bf16 v8, v72, s42, v8
    v_dot2_f32_bf16 v9, v72, v72, v9
    v_dot2_f32_bf16 v10, v80, s42, v10
    v_dot2_f32_bf16 v11, v80, v80, v11
    v_dot2_f32_bf16 v8, v73, s42, v8
    v_dot2_f32_bf16 v9, v73, v73, v9
    v_dot2_f32_bf16 v10, v81, s42, v10
    v_dot2_f32_bf16 v11, v81, v81, v11
    v_dot2_f32_bf16 v8, v74, s42, v8
    v_dot2_f32_bf16 v9, v74, v74, v9
    v_dot2_f32_bf16 v10, v82, s42, v10
    v_dot2_f32_bf16 v11, v82, v82, v11
    v_dot2_f32_bf16 v8, v75, s42, v8
    v_dot2_f32_bf16 v9, v75, v75, v9
    v_dot2_f32_bf16 v10, v83, s42, v10
    v_dot2_f32_bf16 v11, v83, v83, v11
    s_nop 2
    v_permlane16_swap_b32 v8, v10
    v_permlane16_swap_b32 v9, v11
    s_nop 1
    v_pk_add_f32 v[8:9], v[8:9], v[10:11]
    s_nop 0
    v_mov_b32 v10, v8
    v_mov_b32 v11, v9
    s_nop 1
    v_permlane32_swap_b32 v10, v8
    v_permlane32_swap_b32 v11, v9
    s_nop 1
    v_pk_add_f32 v[8:9], v[8:9], v[10:11]
    buffer_store_dwordx2 v[8:9], v115, s[56:59], s39 offen
    s_endpgm
L_L_outB_loader:
    s_lshl_b32 s52, s35, 10
    s_mul_i32 s33, s30, 82944
    s_add_u32 s33, s33, s52
    s_mov_b32 s53, s52
    s_lshl_b32 s38, s31, 2
    s_add_u32 s38, s38, s35
    s_mul_i32 s40, s38, 18432
    s_mul_i32 s41, s35, 18432
    s_add_u32 s41, s41, 82944
    s_cmp_eq_u32 s35, 0
    s_cselect_b32 s34, 0, 0x40000000
    v_add_u32 v7, s34, v15
    s_waitcnt lgkmcnt(0)
    s_add_u32 s16, s4, s59
    s_addc_u32 s17, s5, 0
    s_mov_b32 s18, 0x240000
    s_mov_b32 s19, 0x00020000
    s_add_u32 s12, s4, 0x1900000
    s_addc_u32 s13, s5, 0
    s_mov_b32 s14, 0xa2000
    s_mov_b32 s15, 0x00020000
    s_mov_b32 m0, s41
    s_add_u32 s41, s41, 1024
    buffer_load_dwordx4 v15, s[16:19], s40 offen lds
    s_add_u32 s40, s40, 1024
    s_mov_b32 m0, s41
    s_add_u32 s41, s41, 1024
    buffer_load_dwordx4 v15, s[16:19], s40 offen lds
    s_add_u32 s40, s40, 1024
    s_mov_b32 m0, s53
    s_add_u32 s53, s53, 4096
    buffer_load_dwordx4 v15, s[12:15], s33 offen lds
    s_add_u32 s33, s33, 4096
    s_mov_b32 m0, s53
    s_add_u32 s53, s53, 4096
    buffer_load_dwordx4 v15, s[12:15], s33 offen lds
    s_add_u32 s33, s33, 4096
    s_mov_b32 m0, s53
    s_add_u32 s53, s53, 4096
    buffer_load_dwordx4 v15, s[12:15], s33 offen lds
    s_add_u32 s33, s33, 4096
    s_mov_b32 m0, s41
    s_add_u32 s41, s41, 1024
    buffer_load_dwordx4 v15, s[16:19], s40 offen lds
    s_add_u32 s40, s40, 1024
    s_mov_b32 m0, s41
    s_add_u32 s41, s41, 1024
    buffer_load_dwordx4 v15, s[16:19], s40 offen lds
    s_add_u32 s40, s40, 1024
    s_mov_b32 m0, s53
    s_add_u32 s53, s53, 4096
    buffer_load_dwordx4 v15, s[12:15], s33 offen lds
    s_add_u32 s33, s33, 4096
    s_mov_b32 m0, s53
    s_add_u32 s53, s53, 4096
    buffer_load_dwordx4 v15, s[12:15], s33 offen lds
    s_add_u32 s33, s33, 4096
    s_mov_b32 m0, s41
    s_add_u32 s41, s41, 1024
    buffer_load_dwordx4 v15, s[16:19], s40 offen lds
    s_add_u32 s40, s40, 1024
    s_mov_b32 m0, s41
    s_add_u32 s41, s41, 1024
    buffer_load_dwordx4 v15, s[16:19], s40 offen lds
    s_add_u32 s40, s40, 1024
    s_mov_b32 m0, s53
    s_add_u32 s53, s53, 4096
    buffer_load_dwordx4 v15, s[12:15], s33 offen lds
    s_add_u32 s33, s33, 4096
    s_mov_b32 m0, s53
    s_add_u32 s53, s53, 4096
    buffer_load_dwordx4 v15, s[12:15], s33 offen lds
    s_add_u32 s33, s33, 4096
    s_mov_b32 m0, s41
    s_add_u32 s41, s41, 1024
    buffer_load_dwordx4 v15, s[16:19], s40 offen lds
    s_add_u32 s40, s40, 1024
    s_mov_b32 m0, s41
    s_add_u32 s41, s41, 1024
    buffer_load_dwordx4 v15, s[16:19], s40 offen lds
    s_add_u32 s40, s40, 1024
    s_mov_b32 m0, s53
    s_add_u32 s53, s53, 4096
    buffer_load_dwordx4 v15, s[12:15], s33 offen lds
    s_add_u32 s33, s33, 4096
    s_mov_b32 m0, s53
    s_add_u32 s53, s53, 4096
    buffer_load_dwordx4 v15, s[12:15], s33 offen lds
    s_add_u32 s33, s33, 4096
    s_waitcnt vmcnt(8)
    s_barrier
    s_mov_b32 m0, s41
    s_add_u32 s41, s41, 1024
    buffer_load_dwordx4 v15, s[16:19], s40 offen lds
    s_add_u32 s40, s40, 1024
    s_mov_b32 m0, s41
    s_add_u32 s41, s41, 1024
    buffer_load_dwordx4 v15, s[16:19], s40 offen lds
    s_add_u32 s40, s40, 1024
    s_mov_b32 m0, s53
    s_add_u32 s53, s53, 4096
    buffer_load_dwordx4 v15, s[12:15], s33 offen lds
    s_add_u32 s33, s33, 4096
    s_mov_b32 m0, s53
    s_add_u32 s53, s53, 4096
    buffer_load_dwordx4 v15, s[12:15], s33 offen lds
    s_add_u32 s33, s33, 4096
    s_mov_b32 m0, s53
    s_add_u32 s53, s53, 4096
    buffer_load_dwordx4 v15, s[12:15], s33 offen lds
    s_add_u32 s33, s33, 4096
    s_mov_b32 m0, s41
    s_add_u32 s41, s41, 1024
    buffer_load_dwordx4 v15, s[16:19], s40 offen lds
    s_add_u32 s40, s40, 1024
    s_mov_b32 m0, s41
    s_add_u32 s41, s41, 1024
    buffer_load_dwordx4 v15, s[16:19], s40 offen lds
    s_add_u32 s40, s40, 1024
    s_mov_b32 m0, s53
    s_add_u32 s53, s53, 4096
    buffer_load_dwordx4 v15, s[12:15], s33 offen lds
    s_add_u32 s33, s33, 4096
    s_mov_b32 m0, s53
    s_add_u32 s53, s53, 4096
    buffer_load_dwordx4 v15, s[12:15], s33 offen lds
    s_add_u32 s33, s33, 4096
    s_waitcnt vmcnt(9)
    s_barrier
    s_mov_b32 m0, s41
    s_add_u32 s41, s41, 1024
    buffer_load_dwordx4 v15, s[16:19], s40 offen lds
    s_add_u32 s40, s40, 1024
    s_mov_b32 m0, s41
    s_add_u32 s41, s41, 1024
    buffer_load_dwordx4 v15, s[16:19], s40 offen lds
    s_add_u32 s40, s40, 1024
    s_mov_b32 m0, s53
    s_add_u32 s53, s53, 4096
    buffer_load_dwordx4 v15, s[12:15], s33 offen lds
    s_add_u32 s33, s33, 4096
    s_mov_b32 m0, s53
    s_add_u32 s53, s53, 4096
    buffer_load_dwordx4 v15, s[12:15], s33 offen lds
    s_add_u32 s33, s33, 4096
    s_mov_b32 m0, s41
    s_add_u32 s41, s41, 1024
    buffer_load_dwordx4 v15, s[16:19], s40 offen lds
    s_add_u32 s40, s40, 1024
    s_mov_b32 m0, s41
    s_add_u32 s41, s41, 1024
    buffer_load_dwordx4 v15, s[16:19], s40 offen lds
    s_add_u32 s40, s40, 1024
    s_mov_b32 m0, s53
    s_add_u32 s53, s53, 4096
    buffer_load_dwordx4 v15, s[12:15], s33 offen lds
    s_add_u32 s33, s33, 4096
    s_mov_b32 m0, s53
    s_add_u32 s53, s53, 4096
    buffer_load_dwordx4 v15, s[12:15], s33 offen lds
    s_add_u32 s33, s33, 4096
    s_waitcnt vmcnt(8)
    s_barrier
    s_mov_b32 m0, s41
    s_add_u32 s41, s41, 1024
    buffer_load_dwordx4 v15, s[16:19], s40 offen lds
    s_add_u32 s40, s40, 1024
    s_mov_b32 m0, s41
    s_add_u32 s41, s41, 1024
    buffer_load_dwordx4 v15, s[16:19], s40 offen lds
    s_add_u32 s40, s40, 1024
    s_mov_b32 m0, s53
    s_add_u32 s53, s53, 4096
    buffer_load_dwordx4 v15, s[12:15], s33 offen lds
    s_add_u32 s33, s33, 4096
    s_mov_b32 m0, s53
    s_add_u32 s53, s53, 4096
    buffer_load_dwordx4 v15, s[12:15], s33 offen lds
    s_add_u32 s33, s33, 4096
    s_cmp_eq_u32 s35, 0
    s_cselect_b32 m0, s53, 156672
    s_nop 0
    buffer_load_dwordx4 v7, s[12:15], s33 offen lds
    s_waitcnt vmcnt(9)
    s_barrier
    s_waitcnt vmcnt(5)
    s_barrier
    s_waitcnt vmcnt(0)
    s_barrier
L_L_outB_end:
    s_endpgm
L_text_end:
.section .rodata,"a"
.p2align 6
L_kd_start:
.p2align 6
.amdhsa_kernel prep_kernel
  .amdhsa_next_free_vgpr 64
  .amdhsa_next_free_sgpr 96
  .amdhsa_accum_offset 64
  .amdhsa_group_segment_fixed_size 0
  .amdhsa_kernarg_size 72
  .amdhsa_user_sgpr_count 2
  .amdhsa_user_sgpr_kernarg_segment_ptr 1
  .amdhsa_system_sgpr_workgroup_id_x 1
.end_amdhsa_kernel
.p2align 6
.amdhsa_kernel qkv_a1_kernel
  .amdhsa_next_free_vgpr 232
  .amdhsa_next_free_sgpr 96
  .amdhsa_accum_offset 232
  .amdhsa_group_segment_fixed_size 0
  .amdhsa_kernarg_size 72
  .amdhsa_user_sgpr_count 2
  .amdhsa_user_sgpr_kernarg_segment_ptr 1
  .amdhsa_system_sgpr_workgroup_id_x 1
.end_amdhsa_kernel
.p2align 6
.amdhsa_kernel qkv_a2_kernel
  .amdhsa_next_free_vgpr 232
  .amdhsa_next_free_sgpr 96
  .amdhsa_accum_offset 232
  .amdhsa_group_segment_fixed_size 0
  .amdhsa_kernarg_size 72
  .amdhsa_user_sgpr_count 2
  .amdhsa_user_sgpr_kernarg_segment_ptr 1
  .amdhsa_system_sgpr_workgroup_id_x 1
.end_amdhsa_kernel
.p2align 6
.amdhsa_kernel qkv_b1_kernel
  .amdhsa_next_free_vgpr 232
  .amdhsa_next_free_sgpr 96
  .amdhsa_accum_offset 232
  .amdhsa_group_segment_fixed_size 0
  .amdhsa_kernarg_size 72
  .amdhsa_user_sgpr_count 2
  .amdhsa_user_sgpr_kernarg_segment_ptr 1
  .amdhsa_system_sgpr_workgroup_id_x 1
.end_amdhsa_kernel
.p2align 6
.amdhsa_kernel qkv_b2_kernel
  .amdhsa_next_free_vgpr 232
  .amdhsa_next_free_sgpr 96
  .amdhsa_accum_offset 232
  .amdhsa_group_segment_fixed_size 0
  .amdhsa_kernarg_size 72
  .amdhsa_user_sgpr_count 2
  .amdhsa_user_sgpr_kernarg_segment_ptr 1
  .amdhsa_system_sgpr_workgroup_id_x 1
.end_amdhsa_kernel
.p2align 6
.amdhsa_kernel out_a1_kernel
  .amdhsa_next_free_vgpr 128
  .amdhsa_next_free_sgpr 96
  .amdhsa_accum_offset 128
  .amdhsa_group_segment_fixed_size 0
  .amdhsa_kernarg_size 72
  .amdhsa_user_sgpr_count 2
  .amdhsa_user_sgpr_kernarg_segment_ptr 1
  .amdhsa_system_sgpr_workgroup_id_x 1
.end_amdhsa_kernel
.p2align 6
.amdhsa_kernel out_a2_kernel
  .amdhsa_next_free_vgpr 128
  .amdhsa_next_free_sgpr 96
  .amdhsa_accum_offset 128
  .amdhsa_group_segment_fixed_size 0
  .amdhsa_kernarg_size 72
  .amdhsa_user_sgpr_count 2
  .amdhsa_user_sgpr_kernarg_segment_ptr 1
  .amdhsa_system_sgpr_workgroup_id_x 1
.end_amdhsa_kernel
.p2align 6
.amdhsa_kernel attn_kernel
  .amdhsa_next_free_vgpr 120
  .amdhsa_next_free_sgpr 96
  .amdhsa_accum_offset 120
  .amdhsa_group_segment_fixed_size 0
  .amdhsa_kernarg_size 72
  .amdhsa_user_sgpr_count 2
  .amdhsa_user_sgpr_kernarg_segment_ptr 1
  .amdhsa_system_sgpr_workgroup_id_x 1
.end_amdhsa_kernel
.p2align 6
.amdhsa_kernel out_b1_kernel
  .amdhsa_next_free_vgpr 128
  .amdhsa_next_free_sgpr 96
  .amdhsa_accum_offset 128
  .amdhsa_group_segment_fixed_size 0
  .amdhsa_kernarg_size 72
  .amdhsa_user_sgpr_count 2
  .amdhsa_user_sgpr_kernarg_segment_ptr 1
  .amdhsa_system_sgpr_workgroup_id_x 1
.end_amdhsa_kernel
.p2align 6
.amdhsa_kernel out_b2_kernel
  .amdhsa_next_free_vgpr 128
  .amdhsa_next_free_sgpr 96
  .amdhsa_accum_offset 128
  .amdhsa_group_segment_fixed_size 0
  .amdhsa_kernarg_size 72
  .amdhsa_user_sgpr_count 2
  .amdhsa_user_sgpr_kernarg_segment_ptr 1
  .amdhsa_system_sgpr_workgroup_id_x 1
.end_amdhsa_kernel
```
